```python
import torch

def _softmax(x, axis=-1):
    return torch.softmax(x, dim=axis)
def _gelu(x):
    return torch.nn.functional.gelu(x, approximate="tanh")
def _silu(x):
    return torch.nn.functional.silu(x)
def _sigmoid(x):
    return torch.sigmoid(x)
def _layernorm(x, axis=-1, eps=1e-5):
    m = x.mean(dim=axis, keepdim=True)
    v = x.var(dim=axis, keepdim=True, unbiased=False)
    return (x - m) / torch.sqrt(v + eps)
def _scatter_add(tgt, idx, src, axis=0):
    return tgt.clone().index_add_(axis, idx, src)
def _segment_sum(src, seg, n):
    out = torch.zeros((n,) + src.shape[1:], dtype=src.dtype)
    return out.index_add_(0, seg, src)
def _pad(x, pw):
    flat = tuple(v for pair in reversed(pw) for v in pair)
    return torch.nn.functional.pad(x, flat)

kernel_name = 'recurrent_scan__spectral_gfnet__dense_activation_relu__prompt'

def setup_inputs():

    _w = (lambda a: (lambda t: t.to(torch.bfloat16) if t.is_floating_point() else t)(torch.as_tensor(a)))
    def _A_setup():
        B, S, D = 1, 2048, 512
        Df = D // 2 + 1
        return {
            "x": _w((lambda *s: torch.randn(*s, dtype=torch.bfloat16) * 0.05)(B, S, D)),
            "w_r": _w((lambda *s: torch.randn(*s, dtype=torch.bfloat16) * 0.2)(S, Df) * 0.02),
            "w_i": _w((lambda *s: torch.randn(*s, dtype=torch.bfloat16) * 0.2)(S, Df) * 0.02),
        }
    _A_in = _A_setup()

    def _B_setup():
        B, S, D, Dff = 1, 2048, 512, 1376
        return {
            "x": _w((lambda *s: torch.randn(*s, dtype=torch.bfloat16) * 0.05)(B, S, D)),
            "w1": _w((lambda *s: torch.randn(*s, dtype=torch.bfloat16) * 0.1)(D, Dff)),
            "w2": _w((lambda *s: torch.randn(*s, dtype=torch.bfloat16) * 0.1)(Dff, D)),
        }
    _B_in = _B_setup()

    return {
        "A_x": _A_in["x"],
        "A_w_r": _A_in["w_r"],
        "A_w_i": _A_in["w_i"],
        "B_x": _B_in["x"],
        "B_w1": _B_in["w1"],
        "B_w2": _B_in["w2"],
    }

def reference(A_x, A_w_r, A_w_i, B_x, B_w1, B_w2):
    def _A_ref(x, w_r, w_i):
        B, S, D = x.shape
        X = (lambda x, axes=(-2,-1): torch.fft.rfft2(x.float(), dim=axes))(x, axes=(-2, -1))
        W = w_r + 1j * w_i
        X = X * W
        y = (lambda x, s, axes=(-2,-1): torch.fft.irfft2(x, s=s, dim=axes).to(torch.bfloat16))(X, (S, D), axes=(-2, -1))
        return y

    def _B_ref(x, w1, w2):
        h = torch.einsum("bsd,df->bsf", x, w1)
        zero = torch.zeros_like(h)
        h = torch.maximum(h, zero)
        return torch.einsum("bsf,fd->bsd", h, w2)

    x = A_x
    xn = _layernorm(x, axis=-1)
    s = _A_ref(xn, A_w_r, A_w_i)
    g = _silu(_B_ref(xn, B_w1, B_w2))
    return x + s * g
```

```asm
; @launch grid=(256,1,1) block=(512,1,1) lds=163840
.amdgcn_target "amdgcn-amd-amdhsa--gfx950"
.text
.globl recurrent_scan__spectral_gfnet__dense_activation_relu__prompt_kernel
.p2align 8
.type recurrent_scan__spectral_gfnet__dense_activation_relu__prompt_kernel,@function
recurrent_scan__spectral_gfnet__dense_activation_relu__prompt_kernel:
    s_cmpk_ge_u32 s2, 256
    s_cbranch_scc1 L_end
    s_load_dwordx16 s[4:19], s[0:1], 0
    s_load_dwordx2 s[20:21], s[0:1], 64
    s_getpc_b64 s[60:61]
L_pc:
    v_lshrrev_b32 v2, 6, v0
    s_mov_b32 s62, L_end+4-L_pc
    s_mov_b32 s63, 0x20000
    v_readfirstlane_b32 s64, v2
    v_lshlrev_b32 v3, 7, v2
    s_lshr_b32 s3, s2, 3
    s_lshl_b32 s77, s3, 10
    buffer_load_dword v239, v3, s[60:63], s77 offen
    v_and_b32 v1, 63, v0
    s_and_b32 s74, s2, 7
    s_and_b32 s76, s3, 3
    s_lshl2_add_u32 s66, s74, s76
    s_lshr_b32 s68, s2, 5
    s_and_b32 s68, s68, 6
    v_lshrrev_b32 v248, 3, v1
    v_and_b32 v249, 7, v1
    v_lshlrev_b32 v4, 12, v248
    v_add_lshl_u32 v4, v4, v249, 4
    s_lshr_b32 s76, s64, 2
    s_and_b32 s23, s64, 1
    s_lshl1_add_u32 s23, s23, s76
    s_lshl_b32 s22, s23, 10
    s_and_b32 s76, s64, 2
    s_add_u32 s22, s22, s76
    s_lshl2_add_u32 s22, s66, s22
    s_lshl2_add_u32 s77, s22, s68
    s_lshl_b32 s77, s77, 7
    s_lshl_b32 s26, 1, 21
    s_mov_b32 s27, s63
    s_mov_b32 s30, 1409024
    s_mov_b32 s31, s63
    v_min_u32 v3, 5, v1
    v_lshlrev_b32 v3, 7, v3
    s_lshl3_add_u32 s75, s2, s64
    s_mulk_i32 s75, 768
    s_waitcnt lgkmcnt(0)
    s_mov_b64 s[24:25], s[4:5]
    s_mov_b64 s[28:29], s[12:13]
    buffer_load_dwordx4 v[80:83], v4, s[24:27], s77 offen offset:0
    buffer_load_dwordx4 v[84:87], v4, s[24:27], s77 offen offset:128
    buffer_load_dword v238, v3, s[28:31], s75 offen
L_first:
    s_lshl_b32 s22, s22, 9
    s_and_b32 s65, s64, 3
    s_lshr_b32 s67, s2, 5
    s_mov_b32 s10, 1
    v_lshlrev_b32 v7, 4, v1
    s_mov_b32 s36, s20
    s_mov_b32 s37, s21
    s_mov_b32 s38, 16777216
    s_mov_b32 s39, 0x20000
    s_cmp_ge_u32 s64, 4
    s_cbranch_scc1 L_roleY
    s_setprio 1
    s_mul_i32 s74, s67, 43
    s_lshr_b32 s71, s74, 3
    s_add_u32 s74, s74, 43
    s_lshr_b32 s74, s74, 3
    s_sub_u32 s72, s74, s71
    v_xor_b32 v248, v248, v249
    v_lshlrev_b32 v248, 4, v248
    v_lshl_or_b32 v5, v249, 8, v248
    s_and_b32 s74, s23, 1
    s_lshl_b32 s74, s74, 7
    s_lshl_b32 s76, s65, 14
    s_add_u32 s74, s74, s76
    v_add_u32 v5, s74, v5
    v_lshrrev_b32 v2, 4, v1
    v_and_b32 v3, 15, v1
    v_mov_b32 v6, 1
    s_lshl2_add_u32 s74, s65, 163776
    v_mov_b32 v0, s74
    v_and_b32 v8, 3, v1
    v_lshlrev_b32 v8, 2, v8
    v_add_u32 v8, 163776, v8
    v_mov_b32 v248, 0
    v_lshlrev_b32 v249, 2, v3
    v_add_u32 v249, 163776, v249
    ds_write_b32 v249, v248
    s_lshl_b32 s74, s67, 5
    s_add_u32 s74, s74, s65
    s_add_u32 s74, s74, 1
    v_and_b32 v248, 7, v1
    v_lshl_add_u32 v248, v248, 2, s74
    v_cvt_f32_u32 v23, v248
    v_mul_f32 v23, 0x3b000000, v23
    s_lshl_b32 s74, s68, 6
    v_lshl_add_u32 v248, v2, 3, s74
    v_cvt_f32_u32 v248, v248
    v_bfe_u32 v9, v1, 3, 1
    v_cvt_f32_u32 v249, v9
    v_mul_f32 v249, 0x3e800000, v249
    v_fma_f32 v22, v248, v23, v249
    v_fract_f32 v22, v22
    v_mov_b32 v16, v22
    v_fmamk_f32 v17, v23, 0x3f800000, v22
    v_cos_f32 v18, v16
    v_cos_f32 v19, v17
    v_fmamk_f32 v16, v23, 0x40000000, v22
    v_fmamk_f32 v17, v23, 0x40400000, v22
    v_cvt_pk_bf16_f32 v144, v18, v19
    v_cos_f32 v18, v16
    v_cos_f32 v19, v17
    v_fmamk_f32 v16, v23, 0x40800000, v22
    v_fmamk_f32 v17, v23, 0x40a00000, v22
    v_cvt_pk_bf16_f32 v145, v18, v19
    v_cos_f32 v18, v16
    v_cos_f32 v19, v17
    v_fmamk_f32 v16, v23, 0x40c00000, v22
    v_fmamk_f32 v17, v23, 0x40e00000, v22
    v_cvt_pk_bf16_f32 v146, v18, v19
    v_cos_f32 v18, v16
    v_cos_f32 v19, v17
    s_nop 0
    v_cvt_pk_bf16_f32 v147, v18, v19
    v_fmamk_f32 v16, v23, 0x42000000, v22
    v_fmamk_f32 v17, v23, 0x42040000, v22
    v_cos_f32 v18, v16
    v_cos_f32 v19, v17
    v_fmamk_f32 v16, v23, 0x42080000, v22
    v_fmamk_f32 v17, v23, 0x420c0000, v22
    v_cvt_pk_bf16_f32 v148, v18, v19
    v_cos_f32 v18, v16
    v_cos_f32 v19, v17
    v_fmamk_f32 v16, v23, 0x42100000, v22
    v_fmamk_f32 v17, v23, 0x42140000, v22
    v_cvt_pk_bf16_f32 v149, v18, v19
    v_cos_f32 v18, v16
    v_cos_f32 v19, v17
    v_fmamk_f32 v16, v23, 0x42180000, v22
    v_fmamk_f32 v17, v23, 0x421c0000, v22
    v_cvt_pk_bf16_f32 v150, v18, v19
    v_cos_f32 v18, v16
    v_cos_f32 v19, v17
    s_nop 0
    v_cvt_pk_bf16_f32 v151, v18, v19
    v_fmamk_f32 v16, v23, 0x42800000, v22
    v_fmamk_f32 v17, v23, 0x42820000, v22
    v_cos_f32 v18, v16
    v_cos_f32 v19, v17
    v_fmamk_f32 v16, v23, 0x42840000, v22
    v_fmamk_f32 v17, v23, 0x42860000, v22
    v_cvt_pk_bf16_f32 v152, v18, v19
    v_cos_f32 v18, v16
    v_cos_f32 v19, v17
    v_fmamk_f32 v16, v23, 0x42880000, v22
    v_fmamk_f32 v17, v23, 0x428a0000, v22
    v_cvt_pk_bf16_f32 v153, v18, v19
    v_cos_f32 v18, v16
    v_cos_f32 v19, v17
    v_fmamk_f32 v16, v23, 0x428c0000, v22
    v_fmamk_f32 v17, v23, 0x428e0000, v22
    v_cvt_pk_bf16_f32 v154, v18, v19
    v_cos_f32 v18, v16
    v_cos_f32 v19, v17
    s_nop 0
    v_cvt_pk_bf16_f32 v155, v18, v19
    v_fmamk_f32 v16, v23, 0x42c00000, v22
    v_fmamk_f32 v17, v23, 0x42c20000, v22
    v_cos_f32 v18, v16
    v_cos_f32 v19, v17
    v_fmamk_f32 v16, v23, 0x42c40000, v22
    v_fmamk_f32 v17, v23, 0x42c60000, v22
    v_cvt_pk_bf16_f32 v156, v18, v19
    v_cos_f32 v18, v16
    v_cos_f32 v19, v17
    v_fmamk_f32 v16, v23, 0x42c80000, v22
    v_fmamk_f32 v17, v23, 0x42ca0000, v22
    v_cvt_pk_bf16_f32 v157, v18, v19
    v_cos_f32 v18, v16
    v_cos_f32 v19, v17
    v_fmamk_f32 v16, v23, 0x42cc0000, v22
    v_fmamk_f32 v17, v23, 0x42ce0000, v22
    v_cvt_pk_bf16_f32 v158, v18, v19
    v_cos_f32 v18, v16
    v_cos_f32 v19, v17
    s_nop 0
    v_cvt_pk_bf16_f32 v159, v18, v19
    v_mul_u32_u24 v14, 0x8000, v9
    v_lshl_or_b32 v14, v14, 16, v14
    s_cmp_ge_u32 s65, 2
    s_cselect_b32 s74, 0x80008000, 0
    s_bitcmp1_b32 s65, 0
    s_cselect_b32 s76, 0, 0x80008000
    s_cbranch_scc1 L_fo_1
    v_xor_b32 v248, s74, v14
    v_xor_b32_dpp v160, v144, v248 row_ror:8 row_mask:0xf bank_mask:0xf
    v_xor_b32_dpp v161, v145, v248 row_ror:8 row_mask:0xf bank_mask:0xf
    v_xor_b32_dpp v162, v146, v248 row_ror:8 row_mask:0xf bank_mask:0xf
    v_xor_b32_dpp v163, v147, v248 row_ror:8 row_mask:0xf bank_mask:0xf
    v_xor_b32_dpp v164, v148, v248 row_ror:8 row_mask:0xf bank_mask:0xf
    v_xor_b32_dpp v165, v149, v248 row_ror:8 row_mask:0xf bank_mask:0xf
    v_xor_b32_dpp v166, v150, v248 row_ror:8 row_mask:0xf bank_mask:0xf
    v_xor_b32_dpp v167, v151, v248 row_ror:8 row_mask:0xf bank_mask:0xf
    v_xor_b32_dpp v168, v152, v248 row_ror:8 row_mask:0xf bank_mask:0xf
    v_xor_b32_dpp v169, v153, v248 row_ror:8 row_mask:0xf bank_mask:0xf
    v_xor_b32_dpp v170, v154, v248 row_ror:8 row_mask:0xf bank_mask:0xf
    v_xor_b32_dpp v171, v155, v248 row_ror:8 row_mask:0xf bank_mask:0xf
    v_xor_b32_dpp v172, v156, v248 row_ror:8 row_mask:0xf bank_mask:0xf
    v_xor_b32_dpp v173, v157, v248 row_ror:8 row_mask:0xf bank_mask:0xf
    v_xor_b32_dpp v174, v158, v248 row_ror:8 row_mask:0xf bank_mask:0xf
    v_xor_b32_dpp v175, v159, v248 row_ror:8 row_mask:0xf bank_mask:0xf
    s_branch L_fe_2
L_fo_1:
    s_xor_b32 s74, s74, 0x80008000
    v_xor_b32 v160, s74, v144
    v_xor_b32 v161, s74, v145
    v_xor_b32 v162, s74, v146
    v_xor_b32 v163, s74, v147
    v_xor_b32 v164, s74, v148
    v_xor_b32 v165, s74, v149
    v_xor_b32 v166, s74, v150
    v_xor_b32 v167, s74, v151
    v_xor_b32 v168, s74, v152
    v_xor_b32 v169, s74, v153
    v_xor_b32 v170, s74, v154
    v_xor_b32 v171, s74, v155
    v_xor_b32 v172, s74, v156
    v_xor_b32 v173, s74, v157
    v_xor_b32 v174, s74, v158
    v_xor_b32 v175, s74, v159
L_fe_2:
    s_add_u32 s77, s68, 2
    s_and_b32 s77, s77, 7
    s_lshl_b32 s77, s77, 7
    s_add_u32 s77, s77, s22
    buffer_load_dwordx4 v[88:91], v4, s[24:27], s77 offen offset:0
    s_nop 0
    buffer_load_dwordx4 v[92:95], v4, s[24:27], s77 offen offset:128
    s_add_u32 s77, s68, 4
    s_and_b32 s77, s77, 7
    s_lshl_b32 s77, s77, 7
    s_add_u32 s77, s77, s22
    buffer_load_dwordx4 v[96:99], v4, s[24:27], s77 offen offset:0
    s_nop 0
    buffer_load_dwordx4 v[100:103], v4, s[24:27], s77 offen offset:128
    s_add_u32 s77, s68, 6
    s_and_b32 s77, s77, 7
    s_lshl_b32 s77, s77, 7
    s_add_u32 s77, s77, s22
    buffer_load_dwordx4 v[104:107], v4, s[24:27], s77 offen offset:0
    s_nop 0
    buffer_load_dwordx4 v[108:111], v4, s[24:27], s77 offen offset:128
    s_mov_b32 s40, s16
    s_mov_b32 s41, s17
    s_mov_b32 s42, 2097152
    s_mov_b32 s43, 0x20000
    s_mov_b32 s73, 0xffff0000
    v_xor_b32 v248, v3, v2
    v_lshlrev_b32 v248, 4, v248
    v_lshl_or_b32 v248, v2, 8, v248
    s_lshr_b32 s75, s65, 1
    s_lshl_b32 s74, s75, 15
    v_add_u32 v10, s74, v248
    v_xor_b32 v11, 64, v10
    v_xor_b32 v12, 0x8000, v10
    v_xor_b32 v13, 0x8000, v11
    s_lshl_b32 s74, s75, 12
    s_add_u32 s74, s74, 139264
    v_add_u32 v15, s74, v7
    v_xor_b32 v9, 0x1000, v15
    s_lshl_b32 s74, s65, 9
    s_add_u32 s74, s74, 49152
    v_bfe_u32 v248, v1, 3, 1
    v_mul_u32_u24 v248, 3072, v248
    v_lshl_add_u32 v248, v2, 7, v248
    v_and_b32 v254, 2, v2
    s_and_b32 s77, s65, 2
    v_lshl_add_u32 v254, s77, 1, v254
    v_xor_b32 v254, v254, v1
    v_and_b32 v254, 7, v254
    v_lshl_add_u32 v254, v254, 4, v248
    v_add_u32 v254, s74, v254
    v_lshrrev_b32 v250, 5, v1
    v_mul_u32_u24 v250, 3072, v250
    v_bfe_u32 v248, v1, 2, 3
    v_lshl_add_u32 v250, v248, 7, v250
    v_and_b32 v248, 3, v1
    v_lshl_add_u32 v250, v248, 3, v250
    v_bfe_u32 v248, v1, 3, 2
    v_lshl_add_u32 v250, v248, 5, v250
    s_and_b32 s77, s65, 1
    s_lshl_b32 s75, s77, 6
    s_lshl_b32 s74, s77, 10
    v_xor_b32 v250, s75, v250
    s_add_u32 s75, s74, 65536
    v_add_u32 v250, s75, v250
    v_xor_b32 v251, 32, v250
    v_xad_u32 v252, v250, 64, s74
    v_xor_b32 v253, 32, v252
    s_mul_i32 s4, s66, 176128
    s_mul_i32 s74, s77, 3
    s_add_u32 s75, s74, s71
    s_lshl_b32 s75, s75, 12
    s_add_u32 s4, s4, s75
    s_lshr_b32 s75, s65, 1
    s_lshl_b32 s75, s75, 11
    s_add_u32 s4, s4, s75
    s_add_u32 s4, s4, 7340032
    s_add_u32 s5, s4, 4096
    s_add_u32 s6, s4, 8192
    s_add_u32 s74, s74, 2
    s_cmp_lt_u32 s74, s72
    s_cselect_b32 s6, s6, 16777216
    s_waitcnt lgkmcnt(0)
    s_barrier
    v_mov_b32 v224, 0
    v_mov_b32 v225, 0
    v_mov_b32 v226, 0
    v_mov_b32 v227, 0
    s_mov_b32 s11, 0x3f803f80
    s_waitcnt vmcnt(8)
    v_dot2c_f32_bf16 v224, s11, v80
    v_dot2c_f32_bf16 v226, v80, v80
    v_dot2c_f32_bf16 v225, s11, v81
    v_dot2c_f32_bf16 v227, v81, v81
    v_dot2c_f32_bf16 v224, s11, v82
    v_dot2c_f32_bf16 v226, v82, v82
    v_dot2c_f32_bf16 v225, s11, v83
    v_dot2c_f32_bf16 v227, v83, v83
    s_waitcnt vmcnt(7)
    v_dot2c_f32_bf16 v224, s11, v84
    v_dot2c_f32_bf16 v226, v84, v84
    v_dot2c_f32_bf16 v225, s11, v85
    v_dot2c_f32_bf16 v227, v85, v85
    v_dot2c_f32_bf16 v224, s11, v86
    v_dot2c_f32_bf16 v226, v86, v86
    v_dot2c_f32_bf16 v225, s11, v87
    v_dot2c_f32_bf16 v227, v87, v87
    s_waitcnt vmcnt(5)
    v_dot2c_f32_bf16 v224, s11, v88
    v_dot2c_f32_bf16 v226, v88, v88
    v_dot2c_f32_bf16 v225, s11, v89
    v_dot2c_f32_bf16 v227, v89, v89
    v_dot2c_f32_bf16 v224, s11, v90
    v_dot2c_f32_bf16 v226, v90, v90
    v_dot2c_f32_bf16 v225, s11, v91
    v_dot2c_f32_bf16 v227, v91, v91
    s_waitcnt vmcnt(4)
    v_dot2c_f32_bf16 v224, s11, v92
    v_dot2c_f32_bf16 v226, v92, v92
    v_dot2c_f32_bf16 v225, s11, v93
    v_dot2c_f32_bf16 v227, v93, v93
    v_dot2c_f32_bf16 v224, s11, v94
    v_dot2c_f32_bf16 v226, v94, v94
    v_dot2c_f32_bf16 v225, s11, v95
    v_dot2c_f32_bf16 v227, v95, v95
    s_waitcnt vmcnt(3)
    v_dot2c_f32_bf16 v224, s11, v96
    v_dot2c_f32_bf16 v226, v96, v96
    v_dot2c_f32_bf16 v225, s11, v97
    v_dot2c_f32_bf16 v227, v97, v97
    v_dot2c_f32_bf16 v224, s11, v98
    v_dot2c_f32_bf16 v226, v98, v98
    v_dot2c_f32_bf16 v225, s11, v99
    v_dot2c_f32_bf16 v227, v99, v99
    s_waitcnt vmcnt(2)
    v_dot2c_f32_bf16 v224, s11, v100
    v_dot2c_f32_bf16 v226, v100, v100
    v_dot2c_f32_bf16 v225, s11, v101
    v_dot2c_f32_bf16 v227, v101, v101
    v_dot2c_f32_bf16 v224, s11, v102
    v_dot2c_f32_bf16 v226, v102, v102
    v_dot2c_f32_bf16 v225, s11, v103
    v_dot2c_f32_bf16 v227, v103, v103
    s_waitcnt vmcnt(1)
    v_dot2c_f32_bf16 v224, s11, v104
    v_dot2c_f32_bf16 v226, v104, v104
    v_dot2c_f32_bf16 v225, s11, v105
    v_dot2c_f32_bf16 v227, v105, v105
    v_dot2c_f32_bf16 v224, s11, v106
    v_dot2c_f32_bf16 v226, v106, v106
    v_dot2c_f32_bf16 v225, s11, v107
    v_dot2c_f32_bf16 v227, v107, v107
    s_waitcnt vmcnt(0)
    v_dot2c_f32_bf16 v224, s11, v108
    v_dot2c_f32_bf16 v226, v108, v108
    v_dot2c_f32_bf16 v225, s11, v109
    v_dot2c_f32_bf16 v227, v109, v109
    v_dot2c_f32_bf16 v224, s11, v110
    v_dot2c_f32_bf16 v226, v110, v110
    v_dot2c_f32_bf16 v225, s11, v111
    v_dot2c_f32_bf16 v227, v111, v111
    s_nop 1
    v_add_f32 v224, v224, v225
    v_add_f32 v226, v226, v227
    s_nop 0
    v_add_f32_dpp v224, v224, v224 quad_perm:[1,0,3,2] row_mask:0xf bank_mask:0xf
    v_add_f32_dpp v226, v226, v226 quad_perm:[1,0,3,2] row_mask:0xf bank_mask:0xf
    s_nop 0
    v_add_f32_dpp v224, v224, v224 quad_perm:[2,3,0,1] row_mask:0xf bank_mask:0xf
    v_add_f32_dpp v226, v226, v226 quad_perm:[2,3,0,1] row_mask:0xf bank_mask:0xf
    s_nop 0
    v_add_f32_dpp v224, v224, v224 row_half_mirror row_mask:0xf bank_mask:0xf
    v_add_f32_dpp v226, v226, v226 row_half_mirror row_mask:0xf bank_mask:0xf
    v_mul_f32 v224, 0xbb000000, v224
    v_mul_f32 v226, 0x3b000000, v226
    v_fma_f32 v226, -v224, v224, v226
    v_max_f32 v226, 0, v226
    v_add_f32 v226, 0x3727c5ac, v226
    v_rsq_f32 v226, v226
    s_nop 0
    v_cvt_pk_bf16_f32 v228, v226, 0
    v_lshlrev_b32 v229, 16, v228
    v_mul_f32 v230, v224, v229
    v_dot2_f32_bf16 v112, v80, v228, v230
    v_dot2_f32_bf16 v113, v80, v229, v230
    v_dot2_f32_bf16 v114, v81, v228, v230
    v_dot2_f32_bf16 v115, v81, v229, v230
    v_dot2_f32_bf16 v116, v82, v228, v230
    v_dot2_f32_bf16 v117, v82, v229, v230
    v_dot2_f32_bf16 v118, v83, v228, v230
    v_dot2_f32_bf16 v119, v83, v229, v230
    v_dot2_f32_bf16 v120, v84, v228, v230
    v_dot2_f32_bf16 v121, v84, v229, v230
    v_dot2_f32_bf16 v122, v85, v228, v230
    v_dot2_f32_bf16 v123, v85, v229, v230
    v_dot2_f32_bf16 v124, v86, v228, v230
    v_dot2_f32_bf16 v125, v86, v229, v230
    v_dot2_f32_bf16 v126, v87, v228, v230
    v_dot2_f32_bf16 v127, v87, v229, v230
    v_cvt_pk_bf16_f32 v80, v112, v113
    v_cvt_pk_bf16_f32 v81, v114, v115
    v_cvt_pk_bf16_f32 v82, v116, v117
    v_cvt_pk_bf16_f32 v83, v118, v119
    ds_write_b128 v5, v[80:83] offset:0
    v_dot2_f32_bf16 v112, v88, v228, v230
    v_dot2_f32_bf16 v113, v88, v229, v230
    v_dot2_f32_bf16 v114, v89, v228, v230
    v_dot2_f32_bf16 v115, v89, v229, v230
    v_dot2_f32_bf16 v116, v90, v228, v230
    v_dot2_f32_bf16 v117, v90, v229, v230
    v_dot2_f32_bf16 v118, v91, v228, v230
    v_dot2_f32_bf16 v119, v91, v229, v230
    v_cvt_pk_bf16_f32 v84, v120, v121
    v_cvt_pk_bf16_f32 v85, v122, v123
    v_cvt_pk_bf16_f32 v86, v124, v125
    v_cvt_pk_bf16_f32 v87, v126, v127
    ds_write_b128 v5, v[84:87] offset:2048
    v_dot2_f32_bf16 v120, v92, v228, v230
    v_dot2_f32_bf16 v121, v92, v229, v230
    v_dot2_f32_bf16 v122, v93, v228, v230
    v_dot2_f32_bf16 v123, v93, v229, v230
    v_dot2_f32_bf16 v124, v94, v228, v230
    v_dot2_f32_bf16 v125, v94, v229, v230
    v_dot2_f32_bf16 v126, v95, v228, v230
    v_dot2_f32_bf16 v127, v95, v229, v230
    v_cvt_pk_bf16_f32 v88, v112, v113
    v_cvt_pk_bf16_f32 v89, v114, v115
    v_cvt_pk_bf16_f32 v90, v116, v117
    v_cvt_pk_bf16_f32 v91, v118, v119
    ds_write_b128 v5, v[88:91] offset:4096
    v_dot2_f32_bf16 v112, v96, v228, v230
    v_dot2_f32_bf16 v113, v96, v229, v230
    v_dot2_f32_bf16 v114, v97, v228, v230
    v_dot2_f32_bf16 v115, v97, v229, v230
    v_dot2_f32_bf16 v116, v98, v228, v230
    v_dot2_f32_bf16 v117, v98, v229, v230
    v_dot2_f32_bf16 v118, v99, v228, v230
    v_dot2_f32_bf16 v119, v99, v229, v230
    v_cvt_pk_bf16_f32 v92, v120, v121
    v_cvt_pk_bf16_f32 v93, v122, v123
    v_cvt_pk_bf16_f32 v94, v124, v125
    v_cvt_pk_bf16_f32 v95, v126, v127
    ds_write_b128 v5, v[92:95] offset:6144
    v_dot2_f32_bf16 v120, v100, v228, v230
    v_dot2_f32_bf16 v121, v100, v229, v230
    v_dot2_f32_bf16 v122, v101, v228, v230
    v_dot2_f32_bf16 v123, v101, v229, v230
    v_dot2_f32_bf16 v124, v102, v228, v230
    v_dot2_f32_bf16 v125, v102, v229, v230
    v_dot2_f32_bf16 v126, v103, v228, v230
    v_dot2_f32_bf16 v127, v103, v229, v230
    v_cvt_pk_bf16_f32 v96, v112, v113
    v_cvt_pk_bf16_f32 v97, v114, v115
    v_cvt_pk_bf16_f32 v98, v116, v117
    v_cvt_pk_bf16_f32 v99, v118, v119
    ds_write_b128 v5, v[96:99] offset:8192
    v_dot2_f32_bf16 v112, v104, v228, v230
    v_dot2_f32_bf16 v113, v104, v229, v230
    v_dot2_f32_bf16 v114, v105, v228, v230
    v_dot2_f32_bf16 v115, v105, v229, v230
    v_dot2_f32_bf16 v116, v106, v228, v230
    v_dot2_f32_bf16 v117, v106, v229, v230
    v_dot2_f32_bf16 v118, v107, v228, v230
    v_dot2_f32_bf16 v119, v107, v229, v230
    v_cvt_pk_bf16_f32 v100, v120, v121
    v_cvt_pk_bf16_f32 v101, v122, v123
    v_cvt_pk_bf16_f32 v102, v124, v125
    v_cvt_pk_bf16_f32 v103, v126, v127
    ds_write_b128 v5, v[100:103] offset:10240
    v_dot2_f32_bf16 v120, v108, v228, v230
    v_dot2_f32_bf16 v121, v108, v229, v230
    v_dot2_f32_bf16 v122, v109, v228, v230
    v_dot2_f32_bf16 v123, v109, v229, v230
    v_dot2_f32_bf16 v124, v110, v228, v230
    v_dot2_f32_bf16 v125, v110, v229, v230
    v_dot2_f32_bf16 v126, v111, v228, v230
    v_dot2_f32_bf16 v127, v111, v229, v230
    v_cvt_pk_bf16_f32 v104, v112, v113
    v_cvt_pk_bf16_f32 v105, v114, v115
    v_cvt_pk_bf16_f32 v106, v116, v117
    v_cvt_pk_bf16_f32 v107, v118, v119
    ds_write_b128 v5, v[104:107] offset:12288
    v_cvt_pk_bf16_f32 v108, v120, v121
    v_cvt_pk_bf16_f32 v109, v122, v123
    v_cvt_pk_bf16_f32 v110, v124, v125
    v_cvt_pk_bf16_f32 v111, v126, v127
    ds_write_b128 v5, v[108:111] offset:14336
    s_waitcnt lgkmcnt(0)
    s_barrier
    s_setprio 1
    ds_read_b128 v[16:19], v10 offset:0
    ds_read_b128 v[20:23], v10 offset:16384
    ds_read_b128 v[224:227], v12 offset:0
    ds_read_b128 v[228:231], v12 offset:16384
    ds_read_b128 v[24:27], v11 offset:1024
    ds_read_b128 v[28:31], v11 offset:17408
    ds_read_b128 v[232:235], v13 offset:1024
    ds_read_b128 v[236:239], v13 offset:17408
    s_waitcnt lgkmcnt(6)
    v_mfma_f32_16x16x32_bf16 v[208:211], v[16:19], v[144:147], 0
    ds_read_b128 v[32:35], v10 offset:2048
    v_mfma_f32_16x16x32_bf16 v[212:215], v[20:23], v[144:147], 0
    ds_read_b128 v[36:39], v10 offset:18432
    s_waitcnt lgkmcnt(6)
    v_mfma_f32_16x16x32_bf16 v[216:219], v[224:227], v[144:147], 0
    ds_read_b128 v[240:243], v12 offset:2048
    v_mfma_f32_16x16x32_bf16 v[220:223], v[228:231], v[144:147], 0
    ds_read_b128 v[244:247], v12 offset:18432
    s_waitcnt lgkmcnt(6)
    v_mfma_f32_16x16x32_bf16 v[208:211], v[24:27], v[148:151], v[208:211]
    ds_read_b128 v[40:43], v11 offset:3072
    v_xor_b32 v144, s76, v144
    v_mfma_f32_16x16x32_bf16 v[212:215], v[28:31], v[148:151], v[212:215]
    ds_read_b128 v[44:47], v11 offset:19456
    v_xor_b32 v145, s76, v145
    s_waitcnt lgkmcnt(6)
    v_mfma_f32_16x16x32_bf16 v[216:219], v[232:235], v[148:151], v[216:219]
    ds_read_b128 v[224:227], v13 offset:3072
    v_xor_b32 v146, s76, v146
    v_mfma_f32_16x16x32_bf16 v[220:223], v[236:239], v[148:151], v[220:223]
    ds_read_b128 v[228:231], v13 offset:19456
    v_xor_b32 v147, s76, v147
    s_waitcnt lgkmcnt(6)
    v_mfma_f32_16x16x32_bf16 v[208:211], v[32:35], v[152:155], v[208:211]
    ds_read_b128 v[48:51], v10 offset:4096
    v_xor_b32 v148, s76, v148
    v_mfma_f32_16x16x32_bf16 v[212:215], v[36:39], v[152:155], v[212:215]
    ds_read_b128 v[52:55], v10 offset:20480
    v_xor_b32 v149, s76, v149
    s_waitcnt lgkmcnt(6)
    v_mfma_f32_16x16x32_bf16 v[216:219], v[240:243], v[152:155], v[216:219]
    ds_read_b128 v[232:235], v12 offset:4096
    v_xor_b32 v150, s76, v150
    v_mfma_f32_16x16x32_bf16 v[220:223], v[244:247], v[152:155], v[220:223]
    ds_read_b128 v[236:239], v12 offset:20480
    v_xor_b32 v151, s76, v151
    s_waitcnt lgkmcnt(6)
    v_mfma_f32_16x16x32_bf16 v[208:211], v[40:43], v[156:159], v[208:211]
    ds_read_b128 v[56:59], v11 offset:5120
    v_xor_b32 v152, s76, v152
    v_mfma_f32_16x16x32_bf16 v[212:215], v[44:47], v[156:159], v[212:215]
    ds_read_b128 v[60:63], v11 offset:21504
    v_xor_b32 v153, s76, v153
    s_waitcnt lgkmcnt(6)
    v_mfma_f32_16x16x32_bf16 v[216:219], v[224:227], v[156:159], v[216:219]
    ds_read_b128 v[240:243], v13 offset:5120
    v_xor_b32 v154, s76, v154
    v_mfma_f32_16x16x32_bf16 v[220:223], v[228:231], v[156:159], v[220:223]
    ds_read_b128 v[244:247], v13 offset:21504
    v_xor_b32 v155, s76, v155
    s_waitcnt lgkmcnt(6)
    v_mfma_f32_16x16x32_bf16 v[208:211], v[48:51], v[160:163], v[208:211]
    ds_read_b128 v[64:67], v10 offset:6144
    v_xor_b32 v156, s76, v156
    v_mfma_f32_16x16x32_bf16 v[212:215], v[52:55], v[160:163], v[212:215]
    ds_read_b128 v[68:71], v10 offset:22528
    v_xor_b32 v157, s76, v157
    s_waitcnt lgkmcnt(6)
    v_mfma_f32_16x16x32_bf16 v[216:219], v[232:235], v[160:163], v[216:219]
    ds_read_b128 v[224:227], v12 offset:6144
    v_xor_b32 v158, s76, v158
    v_mfma_f32_16x16x32_bf16 v[220:223], v[236:239], v[160:163], v[220:223]
    ds_read_b128 v[228:231], v12 offset:22528
    v_xor_b32 v159, s76, v159
    s_waitcnt lgkmcnt(6)
    v_mfma_f32_16x16x32_bf16 v[208:211], v[56:59], v[164:167], v[208:211]
    ds_read_b128 v[72:75], v11 offset:7168
    v_xor_b32 v160, s76, v160
    v_mfma_f32_16x16x32_bf16 v[212:215], v[60:63], v[164:167], v[212:215]
    ds_read_b128 v[76:79], v11 offset:23552
    v_xor_b32 v161, s76, v161
    s_waitcnt lgkmcnt(6)
    v_mfma_f32_16x16x32_bf16 v[216:219], v[240:243], v[164:167], v[216:219]
    ds_read_b128 v[232:235], v13 offset:7168
    v_xor_b32 v162, s76, v162
    v_mfma_f32_16x16x32_bf16 v[220:223], v[244:247], v[164:167], v[220:223]
    ds_read_b128 v[236:239], v13 offset:23552
    v_xor_b32 v163, s76, v163
    s_waitcnt lgkmcnt(6)
    v_mfma_f32_16x16x32_bf16 v[208:211], v[64:67], v[168:171], v[208:211]
    ds_read_b128 v[80:83], v10 offset:8192
    v_xor_b32 v164, s76, v164
    v_mfma_f32_16x16x32_bf16 v[212:215], v[68:71], v[168:171], v[212:215]
    ds_read_b128 v[84:87], v10 offset:24576
    v_xor_b32 v165, s76, v165
    s_waitcnt lgkmcnt(6)
    v_mfma_f32_16x16x32_bf16 v[216:219], v[224:227], v[168:171], v[216:219]
    ds_read_b128 v[240:243], v12 offset:8192
    v_xor_b32 v166, s76, v166
    v_mfma_f32_16x16x32_bf16 v[220:223], v[228:231], v[168:171], v[220:223]
    ds_read_b128 v[244:247], v12 offset:24576
    v_xor_b32 v167, s76, v167
    s_waitcnt lgkmcnt(6)
    v_mfma_f32_16x16x32_bf16 v[208:211], v[72:75], v[172:175], v[208:211]
    ds_read_b128 v[88:91], v11 offset:9216
    v_xor_b32 v168, s76, v168
    v_mfma_f32_16x16x32_bf16 v[212:215], v[76:79], v[172:175], v[212:215]
    ds_read_b128 v[92:95], v11 offset:25600
    v_xor_b32 v169, s76, v169
    s_waitcnt lgkmcnt(6)
    v_mfma_f32_16x16x32_bf16 v[216:219], v[232:235], v[172:175], v[216:219]
    ds_read_b128 v[224:227], v13 offset:9216
    v_xor_b32 v170, s76, v170
    v_mfma_f32_16x16x32_bf16 v[220:223], v[236:239], v[172:175], v[220:223]
    ds_read_b128 v[228:231], v13 offset:25600
    v_xor_b32 v171, s76, v171
    s_waitcnt lgkmcnt(6)
    v_mfma_f32_16x16x32_bf16 v[208:211], v[80:83], v[144:147], v[208:211]
    ds_read_b128 v[96:99], v10 offset:10240
    v_xor_b32 v172, s76, v172
    v_mfma_f32_16x16x32_bf16 v[212:215], v[84:87], v[144:147], v[212:215]
    ds_read_b128 v[100:103], v10 offset:26624
    v_xor_b32 v173, s76, v173
    s_waitcnt lgkmcnt(6)
    v_mfma_f32_16x16x32_bf16 v[216:219], v[240:243], v[144:147], v[216:219]
    ds_read_b128 v[232:235], v12 offset:10240
    v_xor_b32 v174, s76, v174
    v_mfma_f32_16x16x32_bf16 v[220:223], v[244:247], v[144:147], v[220:223]
    ds_read_b128 v[236:239], v12 offset:26624
    v_xor_b32 v175, s76, v175
    s_waitcnt lgkmcnt(6)
    v_mfma_f32_16x16x32_bf16 v[208:211], v[88:91], v[148:151], v[208:211]
    ds_read_b128 v[104:107], v11 offset:11264
    v_mfma_f32_16x16x32_bf16 v[212:215], v[92:95], v[148:151], v[212:215]
    ds_read_b128 v[108:111], v11 offset:27648
    s_waitcnt lgkmcnt(6)
    v_mfma_f32_16x16x32_bf16 v[216:219], v[224:227], v[148:151], v[216:219]
    ds_read_b128 v[240:243], v13 offset:11264
    v_mfma_f32_16x16x32_bf16 v[220:223], v[228:231], v[148:151], v[220:223]
    ds_read_b128 v[244:247], v13 offset:27648
    s_waitcnt lgkmcnt(6)
    v_mfma_f32_16x16x32_bf16 v[208:211], v[96:99], v[152:155], v[208:211]
    ds_read_b128 v[112:115], v10 offset:12288
    v_mfma_f32_16x16x32_bf16 v[212:215], v[100:103], v[152:155], v[212:215]
    ds_read_b128 v[116:119], v10 offset:28672
    s_waitcnt lgkmcnt(6)
    v_mfma_f32_16x16x32_bf16 v[216:219], v[232:235], v[152:155], v[216:219]
    ds_read_b128 v[224:227], v12 offset:12288
    v_mfma_f32_16x16x32_bf16 v[220:223], v[236:239], v[152:155], v[220:223]
    ds_read_b128 v[228:231], v12 offset:28672
    s_waitcnt lgkmcnt(6)
    v_mfma_f32_16x16x32_bf16 v[208:211], v[104:107], v[156:159], v[208:211]
    ds_read_b128 v[120:123], v11 offset:13312
    v_mfma_f32_16x16x32_bf16 v[212:215], v[108:111], v[156:159], v[212:215]
    ds_read_b128 v[124:127], v11 offset:29696
    s_waitcnt lgkmcnt(6)
    v_mfma_f32_16x16x32_bf16 v[216:219], v[240:243], v[156:159], v[216:219]
    ds_read_b128 v[232:235], v13 offset:13312
    v_mfma_f32_16x16x32_bf16 v[220:223], v[244:247], v[156:159], v[220:223]
    ds_read_b128 v[236:239], v13 offset:29696
    s_waitcnt lgkmcnt(6)
    v_mfma_f32_16x16x32_bf16 v[208:211], v[112:115], v[160:163], v[208:211]
    ds_read_b128 v[128:131], v10 offset:14336
    v_mfma_f32_16x16x32_bf16 v[212:215], v[116:119], v[160:163], v[212:215]
    ds_read_b128 v[132:135], v10 offset:30720
    s_waitcnt lgkmcnt(6)
    v_mfma_f32_16x16x32_bf16 v[216:219], v[224:227], v[160:163], v[216:219]
    ds_read_b128 v[240:243], v12 offset:14336
    v_mfma_f32_16x16x32_bf16 v[220:223], v[228:231], v[160:163], v[220:223]
    ds_read_b128 v[244:247], v12 offset:30720
    s_waitcnt lgkmcnt(6)
    v_mfma_f32_16x16x32_bf16 v[208:211], v[120:123], v[164:167], v[208:211]
    ds_read_b128 v[136:139], v11 offset:15360
    v_mfma_f32_16x16x32_bf16 v[212:215], v[124:127], v[164:167], v[212:215]
    ds_read_b128 v[140:143], v11 offset:31744
    s_waitcnt lgkmcnt(6)
    v_mfma_f32_16x16x32_bf16 v[216:219], v[232:235], v[164:167], v[216:219]
    ds_read_b128 v[224:227], v13 offset:15360
    v_mfma_f32_16x16x32_bf16 v[220:223], v[236:239], v[164:167], v[220:223]
    ds_read_b128 v[228:231], v13 offset:31744
    s_waitcnt lgkmcnt(6)
    v_mfma_f32_16x16x32_bf16 v[208:211], v[128:131], v[168:171], v[208:211]
    ds_read_b128 v[176:179], v15 offset:0
    v_mfma_f32_16x16x32_bf16 v[212:215], v[132:135], v[168:171], v[212:215]
    ds_read_b128 v[180:183], v15 offset:1024
    s_waitcnt lgkmcnt(6)
    v_mfma_f32_16x16x32_bf16 v[216:219], v[240:243], v[168:171], v[216:219]
    ds_read_b128 v[184:187], v15 offset:2048
    v_mfma_f32_16x16x32_bf16 v[220:223], v[244:247], v[168:171], v[220:223]
    ds_read_b128 v[188:191], v15 offset:3072
    s_waitcnt lgkmcnt(6)
    v_mfma_f32_16x16x32_bf16 v[208:211], v[136:139], v[172:175], v[208:211]
    ds_read_b128 v[192:195], v9 offset:0
    v_mfma_f32_16x16x32_bf16 v[212:215], v[140:143], v[172:175], v[212:215]
    ds_read_b128 v[196:199], v9 offset:1024
    s_waitcnt lgkmcnt(6)
    v_mfma_f32_16x16x32_bf16 v[216:219], v[224:227], v[172:175], v[216:219]
    ds_read_b128 v[200:203], v9 offset:2048
    v_mfma_f32_16x16x32_bf16 v[220:223], v[228:231], v[172:175], v[220:223]
    ds_read_b128 v[204:207], v9 offset:3072
    v_cvt_pk_bf16_f32 v224, v208, v209
    v_cvt_pk_bf16_f32 v225, v210, v211
    v_cvt_pk_bf16_f32 v226, v212, v213
    v_cvt_pk_bf16_f32 v227, v214, v215
    s_nop 0
    v_cvt_pk_bf16_f32 v228, v216, v217
    v_cvt_pk_bf16_f32 v229, v218, v219
    v_cvt_pk_bf16_f32 v230, v220, v221
    v_cvt_pk_bf16_f32 v231, v222, v223
    s_waitcnt lgkmcnt(0)
    s_barrier
    v_mfma_f32_16x16x32_bf16 v[144:147], v[224:227], v[176:179], 0
    v_xor_b32_dpp v232, v224, v14 row_ror:8 row_mask:0xf bank_mask:0xf
    v_xor_b32_dpp v233, v225, v14 row_ror:8 row_mask:0xf bank_mask:0xf
    v_mfma_f32_16x16x32_bf16 v[148:151], v[224:227], v[184:187], 0
    v_xor_b32_dpp v234, v226, v14 row_ror:8 row_mask:0xf bank_mask:0xf
    v_xor_b32_dpp v235, v227, v14 row_ror:8 row_mask:0xf bank_mask:0xf
    v_mfma_f32_16x16x32_bf16 v[152:155], v[228:231], v[192:195], 0
    v_xor_b32_dpp v236, v228, v14 row_ror:8 row_mask:0xf bank_mask:0xf
    v_xor_b32_dpp v237, v229, v14 row_ror:8 row_mask:0xf bank_mask:0xf
    v_mfma_f32_16x16x32_bf16 v[156:159], v[228:231], v[200:203], 0
    v_xor_b32_dpp v238, v230, v14 row_ror:8 row_mask:0xf bank_mask:0xf
    v_xor_b32_dpp v239, v231, v14 row_ror:8 row_mask:0xf bank_mask:0xf
    v_mfma_f32_16x16x32_bf16 v[144:147], v[232:235], v[180:183], v[144:147]
    ds_read_b64_tr_b16 v[208:209], v250 offset:0
    ds_read_b64_tr_b16 v[210:211], v250 offset:6144
    v_mfma_f32_16x16x32_bf16 v[148:151], v[232:235], v[188:191], v[148:151]
    ds_read_b64_tr_b16 v[212:213], v251 offset:0
    ds_read_b64_tr_b16 v[214:215], v251 offset:6144
    v_mfma_f32_16x16x32_bf16 v[152:155], v[236:239], v[196:199], v[152:155]
    ds_read_b64_tr_b16 v[216:217], v252 offset:0
    ds_read_b64_tr_b16 v[218:219], v252 offset:6144
    v_mfma_f32_16x16x32_bf16 v[156:159], v[236:239], v[204:207], v[156:159]
    ds_read_b64_tr_b16 v[220:221], v253 offset:0
    ds_read_b64_tr_b16 v[222:223], v253 offset:6144
    s_nop 2
    v_cvt_pk_bf16_f32 v240, v144, v152
    v_cvt_pk_bf16_f32 v241, v145, v153
    v_cvt_pk_bf16_f32 v242, v146, v154
    v_cvt_pk_bf16_f32 v243, v147, v155
    v_cvt_pk_bf16_f32 v244, v148, v156
    v_cvt_pk_bf16_f32 v245, v149, v157
    v_cvt_pk_bf16_f32 v246, v150, v158
    v_cvt_pk_bf16_f32 v247, v151, v159
    s_waitcnt lgkmcnt(6)
    v_mfma_f32_16x16x32_bf16 v[160:163], v[208:211], v[16:19], 0
    ds_read_b64_tr_b16 v[224:225], v250 offset:1024
    v_mfma_f32_16x16x32_bf16 v[184:187], v[208:211], v[20:23], 0
    ds_read_b64_tr_b16 v[226:227], v250 offset:7168
    ds_write_b128 v254, v[240:243] offset:0
    ds_write_b128 v254, v[244:247] offset:6144
    s_waitcnt lgkmcnt(8)
    v_mfma_f32_16x16x32_bf16 v[164:167], v[212:215], v[16:19], 0
    ds_read_b64_tr_b16 v[228:229], v251 offset:1024
    v_mfma_f32_16x16x32_bf16 v[188:191], v[212:215], v[20:23], 0
    ds_read_b64_tr_b16 v[230:231], v251 offset:7168
    s_waitcnt lgkmcnt(8)
    v_mfma_f32_16x16x32_bf16 v[168:171], v[216:219], v[16:19], 0
    ds_read_b64_tr_b16 v[232:233], v250 offset:12288
    v_mfma_f32_16x16x32_bf16 v[192:195], v[216:219], v[20:23], 0
    ds_read_b64_tr_b16 v[234:235], v250 offset:18432
    s_waitcnt lgkmcnt(8)
    v_mfma_f32_16x16x32_bf16 v[172:175], v[220:223], v[16:19], 0
    ds_read_b64_tr_b16 v[236:237], v251 offset:12288
    v_mfma_f32_16x16x32_bf16 v[196:199], v[220:223], v[20:23], 0
    ds_read_b64_tr_b16 v[238:239], v251 offset:18432
    s_waitcnt lgkmcnt(8)
    v_mfma_f32_16x16x32_bf16 v[176:179], v[224:227], v[16:19], 0
    ds_read_b64_tr_b16 v[208:209], v252 offset:12288
    v_mfma_f32_16x16x32_bf16 v[200:203], v[224:227], v[20:23], 0
    ds_read_b64_tr_b16 v[210:211], v252 offset:18432
    s_waitcnt lgkmcnt(6)
    v_mfma_f32_16x16x32_bf16 v[180:183], v[228:231], v[16:19], 0
    ds_read_b64_tr_b16 v[212:213], v253 offset:12288
    v_mfma_f32_16x16x32_bf16 v[204:207], v[228:231], v[20:23], 0
    ds_read_b64_tr_b16 v[214:215], v253 offset:18432
    s_waitcnt lgkmcnt(6)
    v_mfma_f32_16x16x32_bf16 v[160:163], v[232:235], v[24:27], v[160:163]
    ds_read_b64_tr_b16 v[216:217], v250 offset:13312
    v_mfma_f32_16x16x32_bf16 v[184:187], v[232:235], v[28:31], v[184:187]
    ds_read_b64_tr_b16 v[218:219], v250 offset:19456
    s_waitcnt lgkmcnt(6)
    v_mfma_f32_16x16x32_bf16 v[164:167], v[236:239], v[24:27], v[164:167]
    ds_read_b64_tr_b16 v[220:221], v251 offset:13312
    v_mfma_f32_16x16x32_bf16 v[188:191], v[236:239], v[28:31], v[188:191]
    ds_read_b64_tr_b16 v[222:223], v251 offset:19456
    s_waitcnt lgkmcnt(6)
    s_barrier
    v_mfma_f32_16x16x32_bf16 v[168:171], v[208:211], v[24:27], v[168:171]
    ds_read_b64_tr_b16 v[224:225], v250 offset:24576
    v_mfma_f32_16x16x32_bf16 v[192:195], v[208:211], v[28:31], v[192:195]
    ds_read_b64_tr_b16 v[226:227], v250 offset:30720
    s_waitcnt lgkmcnt(6)
    v_mfma_f32_16x16x32_bf16 v[172:175], v[212:215], v[24:27], v[172:175]
    ds_read_b64_tr_b16 v[228:229], v251 offset:24576
    v_mfma_f32_16x16x32_bf16 v[196:199], v[212:215], v[28:31], v[196:199]
    ds_read_b64_tr_b16 v[230:231], v251 offset:30720
    s_waitcnt lgkmcnt(6)
    v_mfma_f32_16x16x32_bf16 v[176:179], v[216:219], v[24:27], v[176:179]
    ds_read_b64_tr_b16 v[232:233], v252 offset:24576
    v_mfma_f32_16x16x32_bf16 v[200:203], v[216:219], v[28:31], v[200:203]
    ds_read_b64_tr_b16 v[234:235], v252 offset:30720
    s_waitcnt lgkmcnt(6)
    v_mfma_f32_16x16x32_bf16 v[180:183], v[220:223], v[24:27], v[180:183]
    ds_read_b64_tr_b16 v[236:237], v253 offset:24576
    v_mfma_f32_16x16x32_bf16 v[204:207], v[220:223], v[28:31], v[204:207]
    ds_read_b64_tr_b16 v[238:239], v253 offset:30720
    s_waitcnt lgkmcnt(6)
    v_mfma_f32_16x16x32_bf16 v[160:163], v[224:227], v[32:35], v[160:163]
    ds_read_b64_tr_b16 v[208:209], v250 offset:25600
    v_mfma_f32_16x16x32_bf16 v[184:187], v[224:227], v[36:39], v[184:187]
    ds_read_b64_tr_b16 v[210:211], v250 offset:31744
    s_waitcnt lgkmcnt(6)
    v_mfma_f32_16x16x32_bf16 v[164:167], v[228:231], v[32:35], v[164:167]
    ds_read_b64_tr_b16 v[212:213], v251 offset:25600
    v_mfma_f32_16x16x32_bf16 v[188:191], v[228:231], v[36:39], v[188:191]
    ds_read_b64_tr_b16 v[214:215], v251 offset:31744
    s_waitcnt lgkmcnt(6)
    v_mfma_f32_16x16x32_bf16 v[168:171], v[232:235], v[32:35], v[168:171]
    ds_read_b64_tr_b16 v[216:217], v250 offset:36864
    v_mfma_f32_16x16x32_bf16 v[192:195], v[232:235], v[36:39], v[192:195]
    ds_read_b64_tr_b16 v[218:219], v250 offset:43008
    s_waitcnt lgkmcnt(6)
    v_mfma_f32_16x16x32_bf16 v[172:175], v[236:239], v[32:35], v[172:175]
    ds_read_b64_tr_b16 v[220:221], v251 offset:36864
    v_mfma_f32_16x16x32_bf16 v[196:199], v[236:239], v[36:39], v[196:199]
    ds_read_b64_tr_b16 v[222:223], v251 offset:43008
    s_waitcnt lgkmcnt(6)
    v_mfma_f32_16x16x32_bf16 v[176:179], v[208:211], v[32:35], v[176:179]
    ds_read_b64_tr_b16 v[224:225], v252 offset:36864
    v_mfma_f32_16x16x32_bf16 v[200:203], v[208:211], v[36:39], v[200:203]
    ds_read_b64_tr_b16 v[226:227], v252 offset:43008
    s_waitcnt lgkmcnt(6)
    v_mfma_f32_16x16x32_bf16 v[180:183], v[212:215], v[32:35], v[180:183]
    ds_read_b64_tr_b16 v[228:229], v253 offset:36864
    v_mfma_f32_16x16x32_bf16 v[204:207], v[212:215], v[36:39], v[204:207]
    ds_read_b64_tr_b16 v[230:231], v253 offset:43008
    s_waitcnt lgkmcnt(6)
    v_mfma_f32_16x16x32_bf16 v[160:163], v[216:219], v[40:43], v[160:163]
    ds_read_b64_tr_b16 v[232:233], v250 offset:37888
    v_mfma_f32_16x16x32_bf16 v[184:187], v[216:219], v[44:47], v[184:187]
    ds_read_b64_tr_b16 v[234:235], v250 offset:44032
    s_waitcnt lgkmcnt(6)
    v_mfma_f32_16x16x32_bf16 v[164:167], v[220:223], v[40:43], v[164:167]
    ds_read_b64_tr_b16 v[236:237], v251 offset:37888
    v_mfma_f32_16x16x32_bf16 v[188:191], v[220:223], v[44:47], v[188:191]
    ds_read_b64_tr_b16 v[238:239], v251 offset:44032
    s_waitcnt lgkmcnt(6)
    v_mfma_f32_16x16x32_bf16 v[168:171], v[224:227], v[40:43], v[168:171]
    ds_read_b64_tr_b16 v[208:209], v250 offset:49152
    v_mfma_f32_16x16x32_bf16 v[192:195], v[224:227], v[44:47], v[192:195]
    ds_read_b64_tr_b16 v[210:211], v250 offset:55296
    s_waitcnt lgkmcnt(6)
    v_mfma_f32_16x16x32_bf16 v[172:175], v[228:231], v[40:43], v[172:175]
    ds_read_b64_tr_b16 v[212:213], v251 offset:49152
    v_mfma_f32_16x16x32_bf16 v[196:199], v[228:231], v[44:47], v[196:199]
    ds_read_b64_tr_b16 v[214:215], v251 offset:55296
    s_waitcnt lgkmcnt(6)
    v_mfma_f32_16x16x32_bf16 v[176:179], v[232:235], v[40:43], v[176:179]
    ds_read_b64_tr_b16 v[216:217], v252 offset:49152
    v_mfma_f32_16x16x32_bf16 v[200:203], v[232:235], v[44:47], v[200:203]
    ds_read_b64_tr_b16 v[218:219], v252 offset:55296
    s_waitcnt lgkmcnt(6)
    v_mfma_f32_16x16x32_bf16 v[180:183], v[236:239], v[40:43], v[180:183]
    ds_read_b64_tr_b16 v[220:221], v253 offset:49152
    v_mfma_f32_16x16x32_bf16 v[204:207], v[236:239], v[44:47], v[204:207]
    ds_read_b64_tr_b16 v[222:223], v253 offset:55296
    s_waitcnt lgkmcnt(6)
    v_mfma_f32_16x16x32_bf16 v[160:163], v[208:211], v[48:51], v[160:163]
    ds_read_b64_tr_b16 v[224:225], v250 offset:50176
    v_mfma_f32_16x16x32_bf16 v[184:187], v[208:211], v[52:55], v[184:187]
    ds_read_b64_tr_b16 v[226:227], v250 offset:56320
    s_waitcnt lgkmcnt(6)
    v_mfma_f32_16x16x32_bf16 v[164:167], v[212:215], v[48:51], v[164:167]
    ds_read_b64_tr_b16 v[228:229], v251 offset:50176
    v_mfma_f32_16x16x32_bf16 v[188:191], v[212:215], v[52:55], v[188:191]
    ds_read_b64_tr_b16 v[230:231], v251 offset:56320
    s_waitcnt lgkmcnt(6)
    v_mfma_f32_16x16x32_bf16 v[168:171], v[216:219], v[48:51], v[168:171]
    v_add_u32 v250, 61440, v250
    v_add_u32 v251, 61440, v251
    v_add_u32 v252, 61440, v252
    v_add_u32 v253, 61440, v253
    ds_read_b64_tr_b16 v[232:233], v250 offset:0
    v_mfma_f32_16x16x32_bf16 v[192:195], v[216:219], v[52:55], v[192:195]
    ds_read_b64_tr_b16 v[234:235], v250 offset:6144
    s_waitcnt lgkmcnt(6)
    v_mfma_f32_16x16x32_bf16 v[172:175], v[220:223], v[48:51], v[172:175]
    ds_read_b64_tr_b16 v[236:237], v251 offset:0
    v_mfma_f32_16x16x32_bf16 v[196:199], v[220:223], v[52:55], v[196:199]
    ds_read_b64_tr_b16 v[238:239], v251 offset:6144
    s_waitcnt lgkmcnt(6)
    v_mfma_f32_16x16x32_bf16 v[176:179], v[224:227], v[48:51], v[176:179]
    ds_read_b64_tr_b16 v[208:209], v252 offset:0
    v_mfma_f32_16x16x32_bf16 v[200:203], v[224:227], v[52:55], v[200:203]
    ds_read_b64_tr_b16 v[210:211], v252 offset:6144
    s_waitcnt lgkmcnt(6)
    v_mfma_f32_16x16x32_bf16 v[180:183], v[228:231], v[48:51], v[180:183]
    ds_read_b64_tr_b16 v[212:213], v253 offset:0
    v_mfma_f32_16x16x32_bf16 v[204:207], v[228:231], v[52:55], v[204:207]
    ds_read_b64_tr_b16 v[214:215], v253 offset:6144
    s_waitcnt lgkmcnt(6)
    v_mfma_f32_16x16x32_bf16 v[160:163], v[232:235], v[56:59], v[160:163]
    ds_read_b64_tr_b16 v[216:217], v250 offset:1024
    v_mfma_f32_16x16x32_bf16 v[184:187], v[232:235], v[60:63], v[184:187]
    ds_read_b64_tr_b16 v[218:219], v250 offset:7168
    s_waitcnt lgkmcnt(6)
    v_mfma_f32_16x16x32_bf16 v[164:167], v[236:239], v[56:59], v[164:167]
    ds_read_b64_tr_b16 v[220:221], v251 offset:1024
    v_mfma_f32_16x16x32_bf16 v[188:191], v[236:239], v[60:63], v[188:191]
    ds_read_b64_tr_b16 v[222:223], v251 offset:7168
    s_waitcnt lgkmcnt(6)
    v_mfma_f32_16x16x32_bf16 v[168:171], v[208:211], v[56:59], v[168:171]
    ds_read_b64_tr_b16 v[224:225], v250 offset:12288
    v_mfma_f32_16x16x32_bf16 v[192:195], v[208:211], v[60:63], v[192:195]
    ds_read_b64_tr_b16 v[226:227], v250 offset:18432
    s_waitcnt lgkmcnt(6)
    v_mfma_f32_16x16x32_bf16 v[172:175], v[212:215], v[56:59], v[172:175]
    ds_read_b64_tr_b16 v[228:229], v251 offset:12288
    v_mfma_f32_16x16x32_bf16 v[196:199], v[212:215], v[60:63], v[196:199]
    ds_read_b64_tr_b16 v[230:231], v251 offset:18432
    s_waitcnt lgkmcnt(6)
    v_mfma_f32_16x16x32_bf16 v[176:179], v[216:219], v[56:59], v[176:179]
    ds_read_b64_tr_b16 v[232:233], v252 offset:12288
    v_mfma_f32_16x16x32_bf16 v[200:203], v[216:219], v[60:63], v[200:203]
    ds_read_b64_tr_b16 v[234:235], v252 offset:18432
    s_waitcnt lgkmcnt(6)
    v_mfma_f32_16x16x32_bf16 v[180:183], v[220:223], v[56:59], v[180:183]
    ds_read_b64_tr_b16 v[236:237], v253 offset:12288
    v_mfma_f32_16x16x32_bf16 v[204:207], v[220:223], v[60:63], v[204:207]
    ds_read_b64_tr_b16 v[238:239], v253 offset:18432
    s_waitcnt lgkmcnt(6)
    v_mfma_f32_16x16x32_bf16 v[160:163], v[224:227], v[64:67], v[160:163]
    ds_read_b64_tr_b16 v[208:209], v250 offset:13312
    v_mfma_f32_16x16x32_bf16 v[184:187], v[224:227], v[68:71], v[184:187]
    ds_read_b64_tr_b16 v[210:211], v250 offset:19456
    s_waitcnt lgkmcnt(6)
    v_mfma_f32_16x16x32_bf16 v[164:167], v[228:231], v[64:67], v[164:167]
    ds_read_b64_tr_b16 v[212:213], v251 offset:13312
    v_mfma_f32_16x16x32_bf16 v[188:191], v[228:231], v[68:71], v[188:191]
    ds_read_b64_tr_b16 v[214:215], v251 offset:19456
    s_waitcnt lgkmcnt(6)
    v_mfma_f32_16x16x32_bf16 v[168:171], v[232:235], v[64:67], v[168:171]
    s_barrier
    v_add_u32 v250, 4294840320, v250
    v_add_u32 v251, 4294840320, v251
    v_add_u32 v252, 4294840320, v252
    v_add_u32 v253, 4294840320, v253
    ds_read_b64_tr_b16 v[216:217], v250 offset:0
    v_mfma_f32_16x16x32_bf16 v[192:195], v[232:235], v[68:71], v[192:195]
    ds_read_b64_tr_b16 v[218:219], v250 offset:6144
    s_waitcnt lgkmcnt(6)
    v_mfma_f32_16x16x32_bf16 v[172:175], v[236:239], v[64:67], v[172:175]
    ds_read_b64_tr_b16 v[220:221], v251 offset:0
    v_mfma_f32_16x16x32_bf16 v[196:199], v[236:239], v[68:71], v[196:199]
    ds_read_b64_tr_b16 v[222:223], v251 offset:6144
    s_waitcnt lgkmcnt(6)
    v_mfma_f32_16x16x32_bf16 v[176:179], v[208:211], v[64:67], v[176:179]
    ds_read_b64_tr_b16 v[224:225], v252 offset:0
    v_mfma_f32_16x16x32_bf16 v[200:203], v[208:211], v[68:71], v[200:203]
    ds_read_b64_tr_b16 v[226:227], v252 offset:6144
    s_waitcnt lgkmcnt(6)
    v_mfma_f32_16x16x32_bf16 v[180:183], v[212:215], v[64:67], v[180:183]
    ds_read_b64_tr_b16 v[228:229], v253 offset:0
    v_mfma_f32_16x16x32_bf16 v[204:207], v[212:215], v[68:71], v[204:207]
    ds_read_b64_tr_b16 v[230:231], v253 offset:6144
    s_waitcnt lgkmcnt(6)
    v_mfma_f32_16x16x32_bf16 v[160:163], v[216:219], v[72:75], v[160:163]
    ds_read_b64_tr_b16 v[232:233], v250 offset:1024
    v_mfma_f32_16x16x32_bf16 v[184:187], v[216:219], v[76:79], v[184:187]
    ds_read_b64_tr_b16 v[234:235], v250 offset:7168
    s_waitcnt lgkmcnt(6)
    v_mfma_f32_16x16x32_bf16 v[164:167], v[220:223], v[72:75], v[164:167]
    ds_read_b64_tr_b16 v[236:237], v251 offset:1024
    v_mfma_f32_16x16x32_bf16 v[188:191], v[220:223], v[76:79], v[188:191]
    ds_read_b64_tr_b16 v[238:239], v251 offset:7168
    s_waitcnt lgkmcnt(6)
    v_mfma_f32_16x16x32_bf16 v[168:171], v[224:227], v[72:75], v[168:171]
    ds_read_b64_tr_b16 v[208:209], v250 offset:12288
    v_mfma_f32_16x16x32_bf16 v[192:195], v[224:227], v[76:79], v[192:195]
    ds_read_b64_tr_b16 v[210:211], v250 offset:18432
    s_waitcnt lgkmcnt(6)
    v_mfma_f32_16x16x32_bf16 v[172:175], v[228:231], v[72:75], v[172:175]
    ds_read_b64_tr_b16 v[212:213], v251 offset:12288
    v_mfma_f32_16x16x32_bf16 v[196:199], v[228:231], v[76:79], v[196:199]
    ds_read_b64_tr_b16 v[214:215], v251 offset:18432
    s_waitcnt lgkmcnt(6)
    v_mfma_f32_16x16x32_bf16 v[176:179], v[232:235], v[72:75], v[176:179]
    ds_read_b64_tr_b16 v[216:217], v252 offset:12288
    v_mfma_f32_16x16x32_bf16 v[200:203], v[232:235], v[76:79], v[200:203]
    ds_read_b64_tr_b16 v[218:219], v252 offset:18432
    s_waitcnt lgkmcnt(6)
    v_mfma_f32_16x16x32_bf16 v[180:183], v[236:239], v[72:75], v[180:183]
    ds_read_b64_tr_b16 v[220:221], v253 offset:12288
    v_mfma_f32_16x16x32_bf16 v[204:207], v[236:239], v[76:79], v[204:207]
    ds_read_b64_tr_b16 v[222:223], v253 offset:18432
    s_waitcnt lgkmcnt(6)
    v_mfma_f32_16x16x32_bf16 v[160:163], v[208:211], v[80:83], v[160:163]
    ds_read_b64_tr_b16 v[224:225], v250 offset:13312
    v_mfma_f32_16x16x32_bf16 v[184:187], v[208:211], v[84:87], v[184:187]
    ds_read_b64_tr_b16 v[226:227], v250 offset:19456
    s_waitcnt lgkmcnt(6)
    v_mfma_f32_16x16x32_bf16 v[164:167], v[212:215], v[80:83], v[164:167]
    ds_read_b64_tr_b16 v[228:229], v251 offset:13312
    v_mfma_f32_16x16x32_bf16 v[188:191], v[212:215], v[84:87], v[188:191]
    ds_read_b64_tr_b16 v[230:231], v251 offset:19456
    s_waitcnt lgkmcnt(6)
    v_mfma_f32_16x16x32_bf16 v[168:171], v[216:219], v[80:83], v[168:171]
    ds_read_b64_tr_b16 v[232:233], v250 offset:24576
    v_mfma_f32_16x16x32_bf16 v[192:195], v[216:219], v[84:87], v[192:195]
    ds_read_b64_tr_b16 v[234:235], v250 offset:30720
    s_waitcnt lgkmcnt(6)
    v_mfma_f32_16x16x32_bf16 v[172:175], v[220:223], v[80:83], v[172:175]
    ds_read_b64_tr_b16 v[236:237], v251 offset:24576
    v_mfma_f32_16x16x32_bf16 v[196:199], v[220:223], v[84:87], v[196:199]
    ds_read_b64_tr_b16 v[238:239], v251 offset:30720
    s_waitcnt lgkmcnt(6)
    v_mfma_f32_16x16x32_bf16 v[176:179], v[224:227], v[80:83], v[176:179]
    ds_read_b64_tr_b16 v[208:209], v252 offset:24576
    v_mfma_f32_16x16x32_bf16 v[200:203], v[224:227], v[84:87], v[200:203]
    ds_read_b64_tr_b16 v[210:211], v252 offset:30720
    s_waitcnt lgkmcnt(6)
    v_mfma_f32_16x16x32_bf16 v[180:183], v[228:231], v[80:83], v[180:183]
    ds_read_b64_tr_b16 v[212:213], v253 offset:24576
    v_mfma_f32_16x16x32_bf16 v[204:207], v[228:231], v[84:87], v[204:207]
    ds_read_b64_tr_b16 v[214:215], v253 offset:30720
    s_waitcnt lgkmcnt(6)
    v_mfma_f32_16x16x32_bf16 v[160:163], v[232:235], v[88:91], v[160:163]
    ds_read_b64_tr_b16 v[216:217], v250 offset:25600
    v_mfma_f32_16x16x32_bf16 v[184:187], v[232:235], v[92:95], v[184:187]
    ds_read_b64_tr_b16 v[218:219], v250 offset:31744
    s_waitcnt lgkmcnt(6)
    v_mfma_f32_16x16x32_bf16 v[164:167], v[236:239], v[88:91], v[164:167]
    ds_read_b64_tr_b16 v[220:221], v251 offset:25600
    v_mfma_f32_16x16x32_bf16 v[188:191], v[236:239], v[92:95], v[188:191]
    ds_read_b64_tr_b16 v[222:223], v251 offset:31744
    s_waitcnt lgkmcnt(6)
    v_mfma_f32_16x16x32_bf16 v[168:171], v[208:211], v[88:91], v[168:171]
    s_barrier
    ds_read_b64_tr_b16 v[224:225], v250 offset:36864
    v_mfma_f32_16x16x32_bf16 v[192:195], v[208:211], v[92:95], v[192:195]
    ds_read_b64_tr_b16 v[226:227], v250 offset:43008
    s_waitcnt lgkmcnt(6)
    v_mfma_f32_16x16x32_bf16 v[172:175], v[212:215], v[88:91], v[172:175]
    ds_read_b64_tr_b16 v[228:229], v251 offset:36864
    v_mfma_f32_16x16x32_bf16 v[196:199], v[212:215], v[92:95], v[196:199]
    ds_read_b64_tr_b16 v[230:231], v251 offset:43008
    s_waitcnt lgkmcnt(6)
    v_mfma_f32_16x16x32_bf16 v[176:179], v[216:219], v[88:91], v[176:179]
    ds_read_b64_tr_b16 v[232:233], v252 offset:36864
    v_mfma_f32_16x16x32_bf16 v[200:203], v[216:219], v[92:95], v[200:203]
    ds_read_b64_tr_b16 v[234:235], v252 offset:43008
    s_waitcnt lgkmcnt(6)
    v_mfma_f32_16x16x32_bf16 v[180:183], v[220:223], v[88:91], v[180:183]
    ds_read_b64_tr_b16 v[236:237], v253 offset:36864
    v_mfma_f32_16x16x32_bf16 v[204:207], v[220:223], v[92:95], v[204:207]
    ds_read_b64_tr_b16 v[238:239], v253 offset:43008
    s_waitcnt lgkmcnt(6)
    v_mfma_f32_16x16x32_bf16 v[160:163], v[224:227], v[96:99], v[160:163]
    ds_read_b64_tr_b16 v[208:209], v250 offset:37888
    v_mfma_f32_16x16x32_bf16 v[184:187], v[224:227], v[100:103], v[184:187]
    ds_read_b64_tr_b16 v[210:211], v250 offset:44032
    s_waitcnt lgkmcnt(6)
    v_mfma_f32_16x16x32_bf16 v[164:167], v[228:231], v[96:99], v[164:167]
    ds_read_b64_tr_b16 v[212:213], v251 offset:37888
    v_mfma_f32_16x16x32_bf16 v[188:191], v[228:231], v[100:103], v[188:191]
    ds_read_b64_tr_b16 v[214:215], v251 offset:44032
    s_waitcnt lgkmcnt(6)
    v_mfma_f32_16x16x32_bf16 v[168:171], v[232:235], v[96:99], v[168:171]
    ds_read_b64_tr_b16 v[216:217], v250 offset:49152
    v_mfma_f32_16x16x32_bf16 v[192:195], v[232:235], v[100:103], v[192:195]
    ds_read_b64_tr_b16 v[218:219], v250 offset:55296
    s_waitcnt lgkmcnt(6)
    v_mfma_f32_16x16x32_bf16 v[172:175], v[236:239], v[96:99], v[172:175]
    ds_read_b64_tr_b16 v[220:221], v251 offset:49152
    v_mfma_f32_16x16x32_bf16 v[196:199], v[236:239], v[100:103], v[196:199]
    ds_read_b64_tr_b16 v[222:223], v251 offset:55296
    s_waitcnt lgkmcnt(6)
    v_mfma_f32_16x16x32_bf16 v[176:179], v[208:211], v[96:99], v[176:179]
    ds_read_b64_tr_b16 v[224:225], v252 offset:49152
    v_mfma_f32_16x16x32_bf16 v[200:203], v[208:211], v[100:103], v[200:203]
    ds_read_b64_tr_b16 v[226:227], v252 offset:55296
    s_waitcnt lgkmcnt(6)
    v_mfma_f32_16x16x32_bf16 v[180:183], v[212:215], v[96:99], v[180:183]
    ds_read_b64_tr_b16 v[228:229], v253 offset:49152
    v_mfma_f32_16x16x32_bf16 v[204:207], v[212:215], v[100:103], v[204:207]
    ds_read_b64_tr_b16 v[230:231], v253 offset:55296
    s_waitcnt lgkmcnt(6)
    v_mfma_f32_16x16x32_bf16 v[160:163], v[216:219], v[104:107], v[160:163]
    ds_read_b64_tr_b16 v[232:233], v250 offset:50176
    v_mfma_f32_16x16x32_bf16 v[184:187], v[216:219], v[108:111], v[184:187]
    ds_read_b64_tr_b16 v[234:235], v250 offset:56320
    s_waitcnt lgkmcnt(6)
    v_mfma_f32_16x16x32_bf16 v[164:167], v[220:223], v[104:107], v[164:167]
    ds_read_b64_tr_b16 v[236:237], v251 offset:50176
    v_mfma_f32_16x16x32_bf16 v[188:191], v[220:223], v[108:111], v[188:191]
    ds_read_b64_tr_b16 v[238:239], v251 offset:56320
    s_waitcnt lgkmcnt(6)
    v_mfma_f32_16x16x32_bf16 v[168:171], v[224:227], v[104:107], v[168:171]
    s_barrier
    v_add_u32 v250, 65536, v250
    v_add_u32 v251, 65536, v251
    v_add_u32 v252, 65536, v252
    v_add_u32 v253, 65536, v253
    ds_read_b64_tr_b16 v[208:209], v250 offset:0
    v_mfma_f32_16x16x32_bf16 v[192:195], v[224:227], v[108:111], v[192:195]
    ds_read_b64_tr_b16 v[210:211], v250 offset:6144
    s_waitcnt lgkmcnt(6)
    v_mfma_f32_16x16x32_bf16 v[172:175], v[228:231], v[104:107], v[172:175]
    ds_read_b64_tr_b16 v[212:213], v251 offset:0
    v_mfma_f32_16x16x32_bf16 v[196:199], v[228:231], v[108:111], v[196:199]
    ds_read_b64_tr_b16 v[214:215], v251 offset:6144
    s_waitcnt lgkmcnt(6)
    v_mfma_f32_16x16x32_bf16 v[176:179], v[232:235], v[104:107], v[176:179]
    ds_read_b64_tr_b16 v[216:217], v252 offset:0
    v_mfma_f32_16x16x32_bf16 v[200:203], v[232:235], v[108:111], v[200:203]
    ds_read_b64_tr_b16 v[218:219], v252 offset:6144
    s_waitcnt lgkmcnt(6)
    v_mfma_f32_16x16x32_bf16 v[180:183], v[236:239], v[104:107], v[180:183]
    ds_read_b64_tr_b16 v[220:221], v253 offset:0
    v_mfma_f32_16x16x32_bf16 v[204:207], v[236:239], v[108:111], v[204:207]
    ds_read_b64_tr_b16 v[222:223], v253 offset:6144
    s_waitcnt lgkmcnt(6)
    v_mfma_f32_16x16x32_bf16 v[160:163], v[208:211], v[112:115], v[160:163]
    ds_read_b64_tr_b16 v[224:225], v250 offset:1024
    v_mfma_f32_16x16x32_bf16 v[184:187], v[208:211], v[116:119], v[184:187]
    ds_read_b64_tr_b16 v[226:227], v250 offset:7168
    s_waitcnt lgkmcnt(6)
    v_mfma_f32_16x16x32_bf16 v[164:167], v[212:215], v[112:115], v[164:167]
    ds_read_b64_tr_b16 v[228:229], v251 offset:1024
    v_mfma_f32_16x16x32_bf16 v[188:191], v[212:215], v[116:119], v[188:191]
    ds_read_b64_tr_b16 v[230:231], v251 offset:7168
    s_waitcnt lgkmcnt(6)
    v_mfma_f32_16x16x32_bf16 v[168:171], v[216:219], v[112:115], v[168:171]
    ds_read_b64_tr_b16 v[232:233], v250 offset:12288
    v_mfma_f32_16x16x32_bf16 v[192:195], v[216:219], v[116:119], v[192:195]
    ds_read_b64_tr_b16 v[234:235], v250 offset:18432
    s_waitcnt lgkmcnt(6)
    v_mfma_f32_16x16x32_bf16 v[172:175], v[220:223], v[112:115], v[172:175]
    ds_read_b64_tr_b16 v[236:237], v251 offset:12288
    v_mfma_f32_16x16x32_bf16 v[196:199], v[220:223], v[116:119], v[196:199]
    ds_read_b64_tr_b16 v[238:239], v251 offset:18432
    s_waitcnt lgkmcnt(6)
    v_mfma_f32_16x16x32_bf16 v[176:179], v[224:227], v[112:115], v[176:179]
    ds_read_b64_tr_b16 v[208:209], v252 offset:12288
    v_mfma_f32_16x16x32_bf16 v[200:203], v[224:227], v[116:119], v[200:203]
    ds_read_b64_tr_b16 v[210:211], v252 offset:18432
    s_waitcnt lgkmcnt(6)
    v_mfma_f32_16x16x32_bf16 v[180:183], v[228:231], v[112:115], v[180:183]
    ds_read_b64_tr_b16 v[212:213], v253 offset:12288
    v_mfma_f32_16x16x32_bf16 v[204:207], v[228:231], v[116:119], v[204:207]
    ds_read_b64_tr_b16 v[214:215], v253 offset:18432
    s_waitcnt lgkmcnt(6)
    v_mfma_f32_16x16x32_bf16 v[160:163], v[232:235], v[120:123], v[160:163]
    ds_read_b64_tr_b16 v[216:217], v250 offset:13312
    v_mfma_f32_16x16x32_bf16 v[184:187], v[232:235], v[124:127], v[184:187]
    ds_read_b64_tr_b16 v[218:219], v250 offset:19456
    s_waitcnt lgkmcnt(6)
    v_mfma_f32_16x16x32_bf16 v[164:167], v[236:239], v[120:123], v[164:167]
    ds_read_b64_tr_b16 v[220:221], v251 offset:13312
    v_mfma_f32_16x16x32_bf16 v[188:191], v[236:239], v[124:127], v[188:191]
    ds_read_b64_tr_b16 v[222:223], v251 offset:19456
    s_waitcnt lgkmcnt(6)
    v_mfma_f32_16x16x32_bf16 v[168:171], v[208:211], v[120:123], v[168:171]
    s_barrier
    ds_read_b64_tr_b16 v[224:225], v250 offset:24576
    v_mfma_f32_16x16x32_bf16 v[192:195], v[208:211], v[124:127], v[192:195]
    ds_read_b64_tr_b16 v[226:227], v250 offset:30720
    s_waitcnt lgkmcnt(6)
    v_mfma_f32_16x16x32_bf16 v[172:175], v[212:215], v[120:123], v[172:175]
    ds_read_b64_tr_b16 v[228:229], v251 offset:24576
    v_mfma_f32_16x16x32_bf16 v[196:199], v[212:215], v[124:127], v[196:199]
    ds_read_b64_tr_b16 v[230:231], v251 offset:30720
    s_waitcnt lgkmcnt(6)
    v_mfma_f32_16x16x32_bf16 v[176:179], v[216:219], v[120:123], v[176:179]
    ds_read_b64_tr_b16 v[232:233], v252 offset:24576
    v_mfma_f32_16x16x32_bf16 v[200:203], v[216:219], v[124:127], v[200:203]
    ds_read_b64_tr_b16 v[234:235], v252 offset:30720
    s_waitcnt lgkmcnt(6)
    v_mfma_f32_16x16x32_bf16 v[180:183], v[220:223], v[120:123], v[180:183]
    ds_read_b64_tr_b16 v[236:237], v253 offset:24576
    v_mfma_f32_16x16x32_bf16 v[204:207], v[220:223], v[124:127], v[204:207]
    ds_read_b64_tr_b16 v[238:239], v253 offset:30720
    s_waitcnt lgkmcnt(6)
    v_mfma_f32_16x16x32_bf16 v[160:163], v[224:227], v[128:131], v[160:163]
    ds_read_b64_tr_b16 v[208:209], v250 offset:25600
    v_mfma_f32_16x16x32_bf16 v[184:187], v[224:227], v[132:135], v[184:187]
    ds_read_b64_tr_b16 v[210:211], v250 offset:31744
    s_waitcnt lgkmcnt(6)
    v_mfma_f32_16x16x32_bf16 v[164:167], v[228:231], v[128:131], v[164:167]
    ds_read_b64_tr_b16 v[212:213], v251 offset:25600
    v_mfma_f32_16x16x32_bf16 v[188:191], v[228:231], v[132:135], v[188:191]
    ds_read_b64_tr_b16 v[214:215], v251 offset:31744
    s_waitcnt lgkmcnt(6)
    v_mfma_f32_16x16x32_bf16 v[168:171], v[232:235], v[128:131], v[168:171]
    ds_read_b64_tr_b16 v[216:217], v250 offset:36864
    v_mfma_f32_16x16x32_bf16 v[192:195], v[232:235], v[132:135], v[192:195]
    ds_read_b64_tr_b16 v[218:219], v250 offset:43008
    s_waitcnt lgkmcnt(6)
    v_mfma_f32_16x16x32_bf16 v[172:175], v[236:239], v[128:131], v[172:175]
    ds_read_b64_tr_b16 v[220:221], v251 offset:36864
    v_mfma_f32_16x16x32_bf16 v[196:199], v[236:239], v[132:135], v[196:199]
    ds_read_b64_tr_b16 v[222:223], v251 offset:43008
    s_waitcnt lgkmcnt(6)
    v_mfma_f32_16x16x32_bf16 v[176:179], v[208:211], v[128:131], v[176:179]
    ds_read_b64_tr_b16 v[224:225], v252 offset:36864
    v_mfma_f32_16x16x32_bf16 v[200:203], v[208:211], v[132:135], v[200:203]
    ds_read_b64_tr_b16 v[226:227], v252 offset:43008
    s_waitcnt lgkmcnt(6)
    v_mfma_f32_16x16x32_bf16 v[180:183], v[212:215], v[128:131], v[180:183]
    ds_read_b64_tr_b16 v[228:229], v253 offset:36864
    v_mfma_f32_16x16x32_bf16 v[204:207], v[212:215], v[132:135], v[204:207]
    ds_read_b64_tr_b16 v[230:231], v253 offset:43008
    s_waitcnt lgkmcnt(6)
    v_mfma_f32_16x16x32_bf16 v[160:163], v[216:219], v[136:139], v[160:163]
    ds_read_b64_tr_b16 v[232:233], v250 offset:37888
    v_mfma_f32_16x16x32_bf16 v[184:187], v[216:219], v[140:143], v[184:187]
    ds_read_b64_tr_b16 v[234:235], v250 offset:44032
    s_waitcnt lgkmcnt(6)
    v_mfma_f32_16x16x32_bf16 v[164:167], v[220:223], v[136:139], v[164:167]
    ds_read_b64_tr_b16 v[236:237], v251 offset:37888
    v_mfma_f32_16x16x32_bf16 v[188:191], v[220:223], v[140:143], v[188:191]
    ds_read_b64_tr_b16 v[238:239], v251 offset:44032
    s_waitcnt lgkmcnt(6)
    v_mfma_f32_16x16x32_bf16 v[168:171], v[224:227], v[136:139], v[168:171]
    v_mfma_f32_16x16x32_bf16 v[192:195], v[224:227], v[140:143], v[192:195]
    s_waitcnt lgkmcnt(4)
    v_mfma_f32_16x16x32_bf16 v[172:175], v[228:231], v[136:139], v[172:175]
    v_mfma_f32_16x16x32_bf16 v[196:199], v[228:231], v[140:143], v[196:199]
    s_waitcnt lgkmcnt(2)
    v_mfma_f32_16x16x32_bf16 v[176:179], v[232:235], v[136:139], v[176:179]
    v_mfma_f32_16x16x32_bf16 v[200:203], v[232:235], v[140:143], v[200:203]
    s_waitcnt lgkmcnt(0)
    v_mfma_f32_16x16x32_bf16 v[180:183], v[236:239], v[136:139], v[180:183]
    v_mfma_f32_16x16x32_bf16 v[204:207], v[236:239], v[140:143], v[204:207]
    s_setprio 3
    v_cvt_pk_bf16_f32 v16, v160, v161
    v_cvt_pk_bf16_f32 v17, v162, v163
    v_cvt_pk_bf16_f32 v18, v164, v165
    v_cvt_pk_bf16_f32 v19, v166, v167
    v_pk_max_i16 v16, v16, 0
    v_pk_max_i16 v17, v17, 0
    v_pk_max_i16 v18, v18, 0
    v_pk_max_i16 v19, v19, 0
    buffer_store_dwordx4 v[16:19], v7, s[36:39], s4 offen offset:0 sc1
    v_cvt_pk_bf16_f32 v20, v184, v185
    v_cvt_pk_bf16_f32 v21, v186, v187
    v_cvt_pk_bf16_f32 v22, v188, v189
    v_cvt_pk_bf16_f32 v23, v190, v191
    v_pk_max_i16 v20, v20, 0
    v_pk_max_i16 v21, v21, 0
    v_pk_max_i16 v22, v22, 0
    v_pk_max_i16 v23, v23, 0
    buffer_store_dwordx4 v[20:23], v7, s[36:39], s4 offen offset:1024 sc1
    v_cvt_pk_bf16_f32 v24, v168, v169
    v_cvt_pk_bf16_f32 v25, v170, v171
    v_cvt_pk_bf16_f32 v26, v172, v173
    v_cvt_pk_bf16_f32 v27, v174, v175
    v_pk_max_i16 v24, v24, 0
    v_pk_max_i16 v25, v25, 0
    v_pk_max_i16 v26, v26, 0
    v_pk_max_i16 v27, v27, 0
    buffer_store_dwordx4 v[24:27], v7, s[36:39], s5 offen offset:0 sc1
    v_cvt_pk_bf16_f32 v28, v192, v193
    v_cvt_pk_bf16_f32 v29, v194, v195
    v_cvt_pk_bf16_f32 v30, v196, v197
    v_cvt_pk_bf16_f32 v31, v198, v199
    v_pk_max_i16 v28, v28, 0
    v_pk_max_i16 v29, v29, 0
    v_pk_max_i16 v30, v30, 0
    v_pk_max_i16 v31, v31, 0
    buffer_store_dwordx4 v[28:31], v7, s[36:39], s5 offen offset:1024 sc1
    v_cvt_pk_bf16_f32 v32, v176, v177
    v_cvt_pk_bf16_f32 v33, v178, v179
    v_cvt_pk_bf16_f32 v34, v180, v181
    v_cvt_pk_bf16_f32 v35, v182, v183
    v_pk_max_i16 v32, v32, 0
    v_pk_max_i16 v33, v33, 0
    v_pk_max_i16 v34, v34, 0
    v_pk_max_i16 v35, v35, 0
    buffer_store_dwordx4 v[32:35], v7, s[36:39], s6 offen offset:0 sc1
    v_cvt_pk_bf16_f32 v36, v200, v201
    v_cvt_pk_bf16_f32 v37, v202, v203
    v_cvt_pk_bf16_f32 v38, v204, v205
    v_cvt_pk_bf16_f32 v39, v206, v207
    v_pk_max_i16 v36, v36, 0
    v_pk_max_i16 v37, v37, 0
    v_pk_max_i16 v38, v38, 0
    v_pk_max_i16 v39, v39, 0
    buffer_store_dwordx4 v[36:39], v7, s[36:39], s6 offen offset:1024 sc1
    s_setprio 0
    s_and_b32 s74, s65, 1
    s_mul_i32 s74, s74, 12
    s_and_b32 s75, s65, 2
    s_add_u32 s74, s74, s75
    s_lshl_b32 s74, s74, 10
    v_add_u32 v254, s74, v7
    ds_write_b128 v254, v[16:19] offset:8192
    ds_write_b128 v254, v[20:23] offset:9216
    s_bitcmp1_b32 s65, 0
    s_cbranch_scc1 L_ho_3
    ds_write_b128 v254, v[24:27] offset:12288
    ds_write_b128 v254, v[28:31] offset:13312
    ds_write_b128 v254, v[32:35] offset:16384
    ds_write_b128 v254, v[36:39] offset:17408
L_ho_3:
    s_lshl_b32 s74, s67, 5
    s_add_u32 s74, s74, 0
    v_add_u32 v248, s74, v3
    v_cvt_f32_u32 v248, v248
    v_mul_f32 v15, 0x3c000000, v248
    s_mul_i32 s74, s65, 33
    s_and_b32 s74, s74, 0x41
    s_add_u32 s74, s74, 1
    v_mul_u32_u24 v249, 18, v2
    v_and_b32 v249, 34, v249
    v_add_u32 v249, s74, v249
    v_cvt_f32_u32 v249, v249
    v_mul_f32 v249, 0x3b000000, v249
    v_mul_f32 v14, v248, v249
    v_mov_b32 v248, v14
    v_fmamk_f32 v249, v15, 0x3f800000, v14
    v_cos_f32 v250, v248
    v_cos_f32 v251, v249
    v_sin_f32 v252, v248
    v_sin_f32 v253, v249
    v_fmamk_f32 v248, v15, 0x40000000, v14
    v_fmamk_f32 v249, v15, 0x40400000, v14
    v_cvt_pk_bf16_f32 v80, v250, v251
    v_cvt_pk_bf16_f32 v84, v252, v253
    v_cos_f32 v250, v248
    v_cos_f32 v251, v249
    v_sin_f32 v252, v248
    v_sin_f32 v253, v249
    v_fmamk_f32 v248, v15, 0x40800000, v14
    v_fmamk_f32 v249, v15, 0x40a00000, v14
    v_cvt_pk_bf16_f32 v81, v250, v251
    v_cvt_pk_bf16_f32 v85, v252, v253
    v_cos_f32 v250, v248
    v_cos_f32 v251, v249
    v_sin_f32 v252, v248
    v_sin_f32 v253, v249
    v_fmamk_f32 v248, v15, 0x40c00000, v14
    v_fmamk_f32 v249, v15, 0x40e00000, v14
    v_cvt_pk_bf16_f32 v82, v250, v251
    v_cvt_pk_bf16_f32 v86, v252, v253
    v_cos_f32 v250, v248
    v_cos_f32 v251, v249
    v_sin_f32 v252, v248
    v_sin_f32 v253, v249
    v_cvt_pk_bf16_f32 v83, v250, v251
    v_cvt_pk_bf16_f32 v87, v252, v253
    s_lshl_b32 s74, s67, 5
    s_add_u32 s74, s74, 16
    v_add_u32 v248, s74, v3
    v_cvt_f32_u32 v248, v248
    v_mul_f32 v15, 0x3c000000, v248
    s_mul_i32 s74, s65, 33
    s_and_b32 s74, s74, 0x41
    s_add_u32 s74, s74, 1
    v_mul_u32_u24 v249, 18, v2
    v_and_b32 v249, 34, v249
    v_add_u32 v249, s74, v249
    v_cvt_f32_u32 v249, v249
    v_mul_f32 v249, 0x3b000000, v249
    v_mul_f32 v14, v248, v249
    v_mov_b32 v248, v14
    v_fmamk_f32 v249, v15, 0x3f800000, v14
    v_cos_f32 v250, v248
    v_cos_f32 v251, v249
    v_sin_f32 v252, v248
    v_sin_f32 v253, v249
    v_fmamk_f32 v248, v15, 0x40000000, v14
    v_fmamk_f32 v249, v15, 0x40400000, v14
    v_cvt_pk_bf16_f32 v88, v250, v251
    v_cvt_pk_bf16_f32 v92, v252, v253
    v_cos_f32 v250, v248
    v_cos_f32 v251, v249
    v_sin_f32 v252, v248
    v_sin_f32 v253, v249
    v_fmamk_f32 v248, v15, 0x40800000, v14
    v_fmamk_f32 v249, v15, 0x40a00000, v14
    v_cvt_pk_bf16_f32 v89, v250, v251
    v_cvt_pk_bf16_f32 v93, v252, v253
    v_cos_f32 v250, v248
    v_cos_f32 v251, v249
    v_sin_f32 v252, v248
    v_sin_f32 v253, v249
    v_fmamk_f32 v248, v15, 0x40c00000, v14
    v_fmamk_f32 v249, v15, 0x40e00000, v14
    v_cvt_pk_bf16_f32 v90, v250, v251
    v_cvt_pk_bf16_f32 v94, v252, v253
    v_cos_f32 v250, v248
    v_cos_f32 v251, v249
    v_sin_f32 v252, v248
    v_sin_f32 v253, v249
    v_cvt_pk_bf16_f32 v91, v250, v251
    v_cvt_pk_bf16_f32 v95, v252, v253
    v_and_b32 v248, 1, v1
    v_cmp_eq_u32 vcc, 1, v248
    v_bfe_u32 v249, v1, 1, 1
    v_xor_b32 v248, v248, v249
    v_mul_u32_u24 v248, 0x8000, v248
    v_lshl_or_b32 v248, v248, 16, v248
    v_mul_u32_u24 v249, 0x8000, v249
    v_lshl_or_b32 v249, v249, 16, v249
    v_cndmask_b32 v96, v80, v84, vcc
    v_cndmask_b32 v100, v84, v80, vcc
    v_cndmask_b32 v97, v81, v85, vcc
    v_cndmask_b32 v101, v85, v81, vcc
    v_cndmask_b32 v98, v82, v86, vcc
    v_cndmask_b32 v102, v86, v82, vcc
    v_cndmask_b32 v99, v83, v87, vcc
    v_cndmask_b32 v103, v87, v83, vcc
    v_xor_b32 v96, v248, v96
    v_xor_b32 v100, v249, v100
    v_xor_b32 v97, v248, v97
    v_xor_b32 v101, v249, v101
    v_xor_b32 v98, v248, v98
    v_xor_b32 v102, v249, v102
    v_xor_b32 v99, v248, v99
    v_xor_b32 v103, v249, v103
    v_cndmask_b32 v104, v88, v92, vcc
    v_cndmask_b32 v108, v92, v88, vcc
    v_cndmask_b32 v105, v89, v93, vcc
    v_cndmask_b32 v109, v93, v89, vcc
    v_cndmask_b32 v106, v90, v94, vcc
    v_cndmask_b32 v110, v94, v90, vcc
    v_cndmask_b32 v107, v91, v95, vcc
    v_cndmask_b32 v111, v95, v91, vcc
    v_xor_b32 v104, v248, v104
    v_xor_b32 v108, v249, v108
    v_xor_b32 v105, v248, v105
    v_xor_b32 v109, v249, v109
    v_xor_b32 v106, v248, v106
    v_xor_b32 v110, v249, v110
    v_xor_b32 v107, v248, v107
    v_xor_b32 v111, v249, v111
    s_waitcnt vmcnt(0) lgkmcnt(0)
    s_mov_b64 exec, 1
    ds_add_rtn_u32 v248, v8, v6 offset:0
    s_waitcnt lgkmcnt(0)
    v_cmp_eq_u32 vcc, 3, v248
    s_mov_b64 exec, -1
    s_cbranch_vccz L_hf_4
    s_lshl_b32 s74, s66, 7
    s_add_u32 s74, s74, 8192
    s_atomic_add s10, s[20:21], s74
L_hf_4:
    s_and_b32 s74, s65, 1
    s_lshl_b32 s74, s74, 10
    s_lshr_b32 s75, s65, 1
    s_add_u32 s74, s74, s75
    s_lshl1_add_u32 s74, s66, s74
    v_lshl_add_u32 v248, v3, 6, s74
    v_cvt_f32_u32 v248, v248
    v_mul_f32 v15, 0x3b000000, v248
    v_cvt_f32_u32 v249, v2
    v_mul_f32 v249, 0x3a000000, v249
    v_mul_f32 v14, v248, v249
    v_mov_b32 v248, v14
    v_fmamk_f32 v249, v15, 0x3f800000, v14
    v_cos_f32 v250, v248
    v_cos_f32 v251, v249
    v_sin_f32 v252, v248
    v_sin_f32 v253, v249
    v_fmamk_f32 v248, v15, 0x40000000, v14
    v_fmamk_f32 v249, v15, 0x40400000, v14
    v_cvt_pk_bf16_f32 v112, v250, v251
    v_cvt_pk_bf16_f32 v116, -v252, -v253
    v_cos_f32 v250, v248
    v_cos_f32 v251, v249
    v_sin_f32 v252, v248
    v_sin_f32 v253, v249
    v_fmamk_f32 v248, v15, 0x40800000, v14
    v_fmamk_f32 v249, v15, 0x40a00000, v14
    v_cvt_pk_bf16_f32 v113, v250, v251
    v_cvt_pk_bf16_f32 v117, -v252, -v253
    v_cos_f32 v250, v248
    v_cos_f32 v251, v249
    v_sin_f32 v252, v248
    v_sin_f32 v253, v249
    v_fmamk_f32 v248, v15, 0x40c00000, v14
    v_fmamk_f32 v249, v15, 0x40e00000, v14
    v_cvt_pk_bf16_f32 v114, v250, v251
    v_cvt_pk_bf16_f32 v118, -v252, -v253
    v_cos_f32 v250, v248
    v_cos_f32 v251, v249
    v_sin_f32 v252, v248
    v_sin_f32 v253, v249
    v_cvt_pk_bf16_f32 v115, v250, v251
    v_cvt_pk_bf16_f32 v119, -v252, -v253
    s_lshl_b32 s74, s65, 11
    v_add_u32 v248, s74, v7
    ds_write_b128 v248, v[112:115] offset:0
    ds_write_b128 v248, v[116:119] offset:1024
    v_mov_b32 v249, 8
    ds_write_b32 v0, v249 offset:16
    v_and_b32 v248, 7, v1
    v_xor_b32 v249, v248, v2
    v_lshlrev_b32 v249, 4, v249
    v_lshl_or_b32 v249, v3, 7, v249
    s_lshl_b32 s74, s65, 13
    s_add_u32 s74, s74, 114688
    v_add_u32 v4, s74, v249
    v_xor_b32 v5, 64, v4
    s_lshl_b32 s74, s65, 2
    v_add_u32 v249, s74, v2
    v_and_b32 v250, 7, v249
    v_xor_b32 v248, v248, v250
    v_lshlrev_b32 v248, 4, v248
    v_lshl_or_b32 v248, v249, 7, v248
    v_add_u32 v11, 114688, v248
    v_xor_b32 v248, v3, v250
    v_lshlrev_b32 v248, 4, v248
    v_lshl_or_b32 v12, v249, 8, v248
    v_add_u32 v12, 24576, v12
    v_bfe_u32 v13, v1, 2, 2
    v_mul_u32_u24 v13, 66560, v13
    v_lshrrev_b32 v248, 5, v1
    v_lshl_add_u32 v13, v248, 13, v13
    v_and_b32 v248, 1, v2
    v_lshl_add_u32 v13, v248, 6, v13
    v_and_b32 v248, 3, v1
    v_lshl_add_u32 v13, v248, 4, v13
    s_and_b32 s7, s65, 1
    s_lshl1_add_u32 s7, s66, s7
    s_lshl_b32 s7, s7, 7
    s_lshr_b32 s74, s65, 1
    s_lshl_b32 s74, s74, 14
    s_add_u32 s7, s7, s74
    s_add_u32 s7, s7, 2097152
    ds_read_b32 v248, v8 offset:16
    s_waitcnt lgkmcnt(0)
    v_cmp_gt_u32 vcc, 8, v248
    s_nop 0
    s_cbranch_vccnz L_slow_5
L_back_6:
    ds_read_b128 v[112:115], v7 offset:0
    ds_read_b128 v[116:119], v7 offset:1024
    ds_read_b128 v[120:123], v7 offset:2048
    ds_read_b128 v[124:127], v7 offset:3072
    ds_read_b128 v[128:131], v7 offset:4096
    ds_read_b128 v[132:135], v7 offset:5120
    ds_read_b128 v[136:139], v7 offset:6144
    ds_read_b128 v[140:143], v7 offset:7168
    s_setprio 3
    v_lshlrev_b32 v255, 16, v2
    v_bfe_u32 v248, v1, 3, 1
    v_lshl_or_b32 v255, v248, 9, v255
    v_and_b32 v248, 7, v1
    v_lshl_or_b32 v255, v248, 3, v255
    s_lshl_b32 s8, s65, 18
    s_lshl_b32 s74, s66, 11
    s_add_u32 s8, s8, s74
    s_lshl_b32 s74, s67, 6
    s_add_u32 s8, s8, s74
    s_add_u32 s9, s8, 1048576
    buffer_load_dwordx2 v[240:241], v255, s[24:27], s8 offen offset:0
    buffer_load_dwordx2 v[242:243], v255, s[24:27], s9 offen offset:0
    buffer_load_dwordx2 v[244:245], v255, s[24:27], s8 offen offset:1024
    buffer_load_dwordx2 v[246:247], v255, s[24:27], s9 offen offset:1024
    v_mov_b32 v249, 163776
    s_cmp_lg_u32 s64, 0
    s_cbranch_scc1 L_x0_7
    s_and_b32 s74, s67, 0
    s_lshl_b32 s74, s74, 5
    s_add_u32 s74, s74, s66
    s_lshl_b32 s74, s74, 7
    s_add_u32 s74, s74, 8192
    s_mov_b32 s77, 0
L_ss_8:
    s_load_dword s11, s[20:21], s74 glc
L_ss_8_c:
    s_waitcnt lgkmcnt(0)
    s_cmp_ge_u32 s11, 8
    s_cbranch_scc1 L_sd_9
    s_add_u32 s77, s77, 1
    s_cmp_gt_u32 s77, 30000
    s_cbranch_scc1 L_sd_9
    s_sleep 2
    s_branch L_ss_8
L_sd_9:
    ds_write_b32 v249, v6 offset:8
L_x0_7:
    s_mov_b32 s77, 0
L_ls_10:
    ds_read_b32 v248, v249 offset:8
    s_waitcnt lgkmcnt(0)
    v_cmp_ne_u32 vcc, 1, v248
    s_add_u32 s77, s77, 1
    s_nop 0
    s_cbranch_vccz L_ld_11
    s_cmp_gt_u32 s77, 0x80000
    s_cbranch_scc1 L_ld_11
    s_sleep 1
    s_branch L_ls_10
L_ld_11:
    s_add_u32 s74, s7, 0
    buffer_load_dwordx4 v[16:19], v13, s[36:39], s74 offen sc1
    s_add_u32 s74, s7, 32768
    buffer_load_dwordx4 v[20:23], v13, s[36:39], s74 offen sc1
    s_add_u32 s74, s7, 266240
    buffer_load_dwordx4 v[24:27], v13, s[36:39], s74 offen sc1
    s_add_u32 s74, s7, 299008
    buffer_load_dwordx4 v[28:31], v13, s[36:39], s74 offen sc1
    s_add_u32 s74, s7, 532480
    buffer_load_dwordx4 v[32:35], v13, s[36:39], s74 offen sc1
    s_add_u32 s74, s7, 565248
    buffer_load_dwordx4 v[36:39], v13, s[36:39], s74 offen sc1
    s_add_u32 s74, s7, 798720
    buffer_load_dwordx4 v[40:43], v13, s[36:39], s74 offen sc1
    s_add_u32 s74, s7, 831488
    buffer_load_dwordx4 v[44:47], v13, s[36:39], s74 offen sc1
    s_add_u32 s74, s7, 1064960
    buffer_load_dwordx4 v[48:51], v13, s[36:39], s74 offen sc1
    s_add_u32 s74, s7, 1097728
    buffer_load_dwordx4 v[52:55], v13, s[36:39], s74 offen sc1
    s_add_u32 s74, s7, 1331200
    buffer_load_dwordx4 v[56:59], v13, s[36:39], s74 offen sc1
    s_add_u32 s74, s7, 1363968
    buffer_load_dwordx4 v[60:63], v13, s[36:39], s74 offen sc1
    s_add_u32 s74, s7, 1597440
    buffer_load_dwordx4 v[64:67], v13, s[36:39], s74 offen sc1
    s_add_u32 s74, s7, 1630208
    buffer_load_dwordx4 v[68:71], v13, s[36:39], s74 offen sc1
    s_add_u32 s74, s7, 1863680
    buffer_load_dwordx4 v[72:75], v13, s[36:39], s74 offen sc1
    s_add_u32 s74, s7, 1896448
    buffer_load_dwordx4 v[76:79], v13, s[36:39], s74 offen sc1
    s_waitcnt vmcnt(12)
    s_mov_b32 s77, 0
L_vc_12:
    v_bitop3_b32 v9, v16, v20, 1 bitop3:0x80
    v_bitop3_b32 v9, v24, v28, v9 bitop3:0x80
    v_cmp_eq_u32 vcc, 0, v9
    s_add_u32 s77, s77, 1
    s_nop 0
    s_cbranch_vccz L_vd_13
    s_cmp_gt_u32 s77, 20000
    s_cbranch_scc1 L_vd_13
    s_sleep 2
    s_add_u32 s74, s7, 0
    buffer_load_dwordx4 v[16:19], v13, s[36:39], s74 offen sc1
    s_add_u32 s74, s7, 32768
    buffer_load_dwordx4 v[20:23], v13, s[36:39], s74 offen sc1
    s_add_u32 s74, s7, 266240
    buffer_load_dwordx4 v[24:27], v13, s[36:39], s74 offen sc1
    s_add_u32 s74, s7, 299008
    buffer_load_dwordx4 v[28:31], v13, s[36:39], s74 offen sc1
    s_waitcnt vmcnt(0)
    s_branch L_vc_12
L_vd_13:
    v_mfma_f32_16x16x32_bf16 v[144:147], v[16:19], v[80:83], 0
    v_mfma_f32_16x16x32_bf16 v[148:151], v[16:19], v[84:87], 0
    v_mfma_f32_16x16x32_bf16 v[160:163], v[24:27], v[80:83], 0
    v_mfma_f32_16x16x32_bf16 v[164:167], v[24:27], v[84:87], 0
    v_mfma_f32_16x16x32_bf16 v[144:147], v[20:23], v[96:99], v[144:147]
    v_mfma_f32_16x16x32_bf16 v[148:151], v[20:23], v[100:103], v[148:151]
    v_mfma_f32_16x16x32_bf16 v[160:163], v[28:31], v[96:99], v[160:163]
    v_mfma_f32_16x16x32_bf16 v[164:167], v[28:31], v[100:103], v[164:167]
    v_mfma_f32_16x16x32_bf16 v[152:155], v[16:19], v[88:91], 0
    v_mfma_f32_16x16x32_bf16 v[156:159], v[16:19], v[92:95], 0
    v_mfma_f32_16x16x32_bf16 v[168:171], v[24:27], v[88:91], 0
    v_mfma_f32_16x16x32_bf16 v[172:175], v[24:27], v[92:95], 0
    v_mfma_f32_16x16x32_bf16 v[152:155], v[20:23], v[104:107], v[152:155]
    v_mfma_f32_16x16x32_bf16 v[156:159], v[20:23], v[108:111], v[156:159]
    v_mfma_f32_16x16x32_bf16 v[168:171], v[28:31], v[104:107], v[168:171]
    v_mfma_f32_16x16x32_bf16 v[172:175], v[28:31], v[108:111], v[172:175]
    s_waitcnt vmcnt(8)
    s_mov_b32 s77, 0
L_vc_14:
    v_bitop3_b32 v9, v32, v36, 1 bitop3:0x80
    v_bitop3_b32 v9, v40, v44, v9 bitop3:0x80
    v_cmp_eq_u32 vcc, 0, v9
    s_add_u32 s77, s77, 1
    s_nop 0
    s_cbranch_vccz L_vd_15
    s_cmp_gt_u32 s77, 20000
    s_cbranch_scc1 L_vd_15
    s_sleep 2
    s_add_u32 s74, s7, 532480
    buffer_load_dwordx4 v[32:35], v13, s[36:39], s74 offen sc1
    s_add_u32 s74, s7, 565248
    buffer_load_dwordx4 v[36:39], v13, s[36:39], s74 offen sc1
    s_add_u32 s74, s7, 798720
    buffer_load_dwordx4 v[40:43], v13, s[36:39], s74 offen sc1
    s_add_u32 s74, s7, 831488
    buffer_load_dwordx4 v[44:47], v13, s[36:39], s74 offen sc1
    s_waitcnt vmcnt(0)
    s_branch L_vc_14
L_vd_15:
    v_mfma_f32_16x16x32_bf16 v[176:179], v[32:35], v[80:83], 0
    v_sub_f32 v144, v144, v149
    v_add_f32 v148, v148, v145
    v_mfma_f32_16x16x32_bf16 v[180:183], v[32:35], v[84:87], 0
    v_sub_f32 v160, v160, v165
    v_add_f32 v164, v164, v161
    v_mfma_f32_16x16x32_bf16 v[192:195], v[40:43], v[80:83], 0
    v_cvt_pk_bf16_f32 v208, v144, v160
    v_cvt_pk_bf16_f32 v212, v148, v164
    v_mfma_f32_16x16x32_bf16 v[196:199], v[40:43], v[84:87], 0
    v_sub_f32 v146, v146, v151
    v_add_f32 v150, v150, v147
    v_mfma_f32_16x16x32_bf16 v[176:179], v[36:39], v[96:99], v[176:179]
    v_sub_f32 v162, v162, v167
    v_add_f32 v166, v166, v163
    v_mfma_f32_16x16x32_bf16 v[180:183], v[36:39], v[100:103], v[180:183]
    v_cvt_pk_bf16_f32 v224, v146, v162
    v_cvt_pk_bf16_f32 v228, v150, v166
    v_mfma_f32_16x16x32_bf16 v[192:195], v[44:47], v[96:99], v[192:195]
    v_sub_f32 v152, v152, v157
    v_add_f32 v156, v156, v153
    v_mfma_f32_16x16x32_bf16 v[196:199], v[44:47], v[100:103], v[196:199]
    v_sub_f32 v168, v168, v173
    v_add_f32 v172, v172, v169
    v_mfma_f32_16x16x32_bf16 v[184:187], v[32:35], v[88:91], 0
    v_cvt_pk_bf16_f32 v216, v152, v168
    v_cvt_pk_bf16_f32 v220, v156, v172
    v_mfma_f32_16x16x32_bf16 v[188:191], v[32:35], v[92:95], 0
    v_sub_f32 v154, v154, v159
    v_add_f32 v158, v158, v155
    v_mfma_f32_16x16x32_bf16 v[200:203], v[40:43], v[88:91], 0
    v_sub_f32 v170, v170, v175
    v_add_f32 v174, v174, v171
    v_mfma_f32_16x16x32_bf16 v[204:207], v[40:43], v[92:95], 0
    v_cvt_pk_bf16_f32 v232, v154, v170
    v_cvt_pk_bf16_f32 v236, v158, v174
    v_mfma_f32_16x16x32_bf16 v[184:187], v[36:39], v[104:107], v[184:187]
    v_mfma_f32_16x16x32_bf16 v[188:191], v[36:39], v[108:111], v[188:191]
    v_mfma_f32_16x16x32_bf16 v[200:203], v[44:47], v[104:107], v[200:203]
    v_mfma_f32_16x16x32_bf16 v[204:207], v[44:47], v[108:111], v[204:207]
    s_waitcnt vmcnt(4)
    s_mov_b32 s77, 0
L_vc_16:
    v_bitop3_b32 v9, v48, v52, 1 bitop3:0x80
    v_bitop3_b32 v9, v56, v60, v9 bitop3:0x80
    v_cmp_eq_u32 vcc, 0, v9
    s_add_u32 s77, s77, 1
    s_nop 0
    s_cbranch_vccz L_vd_17
    s_cmp_gt_u32 s77, 20000
    s_cbranch_scc1 L_vd_17
    s_sleep 2
    s_add_u32 s74, s7, 1064960
    buffer_load_dwordx4 v[48:51], v13, s[36:39], s74 offen sc1
    s_add_u32 s74, s7, 1097728
    buffer_load_dwordx4 v[52:55], v13, s[36:39], s74 offen sc1
    s_add_u32 s74, s7, 1331200
    buffer_load_dwordx4 v[56:59], v13, s[36:39], s74 offen sc1
    s_add_u32 s74, s7, 1363968
    buffer_load_dwordx4 v[60:63], v13, s[36:39], s74 offen sc1
    s_waitcnt vmcnt(0)
    s_branch L_vc_16
L_vd_17:
    v_mfma_f32_16x16x32_bf16 v[144:147], v[48:51], v[80:83], 0
    v_sub_f32 v176, v176, v181
    v_add_f32 v180, v180, v177
    v_mfma_f32_16x16x32_bf16 v[148:151], v[48:51], v[84:87], 0
    v_sub_f32 v192, v192, v197
    v_add_f32 v196, v196, v193
    v_mfma_f32_16x16x32_bf16 v[160:163], v[56:59], v[80:83], 0
    v_cvt_pk_bf16_f32 v209, v176, v192
    v_cvt_pk_bf16_f32 v213, v180, v196
    v_mfma_f32_16x16x32_bf16 v[164:167], v[56:59], v[84:87], 0
    v_sub_f32 v178, v178, v183
    v_add_f32 v182, v182, v179
    v_mfma_f32_16x16x32_bf16 v[144:147], v[52:55], v[96:99], v[144:147]
    v_sub_f32 v194, v194, v199
    v_add_f32 v198, v198, v195
    v_mfma_f32_16x16x32_bf16 v[148:151], v[52:55], v[100:103], v[148:151]
    v_cvt_pk_bf16_f32 v225, v178, v194
    v_cvt_pk_bf16_f32 v229, v182, v198
    v_mfma_f32_16x16x32_bf16 v[160:163], v[60:63], v[96:99], v[160:163]
    v_sub_f32 v184, v184, v189
    v_add_f32 v188, v188, v185
    v_mfma_f32_16x16x32_bf16 v[164:167], v[60:63], v[100:103], v[164:167]
    v_sub_f32 v200, v200, v205
    v_add_f32 v204, v204, v201
    v_mfma_f32_16x16x32_bf16 v[152:155], v[48:51], v[88:91], 0
    v_cvt_pk_bf16_f32 v217, v184, v200
    v_cvt_pk_bf16_f32 v221, v188, v204
    v_mfma_f32_16x16x32_bf16 v[156:159], v[48:51], v[92:95], 0
    v_sub_f32 v186, v186, v191
    v_add_f32 v190, v190, v187
    v_mfma_f32_16x16x32_bf16 v[168:171], v[56:59], v[88:91], 0
    v_sub_f32 v202, v202, v207
    v_add_f32 v206, v206, v203
    v_mfma_f32_16x16x32_bf16 v[172:175], v[56:59], v[92:95], 0
    v_cvt_pk_bf16_f32 v233, v186, v202
    v_cvt_pk_bf16_f32 v237, v190, v206
    v_mfma_f32_16x16x32_bf16 v[152:155], v[52:55], v[104:107], v[152:155]
    v_mfma_f32_16x16x32_bf16 v[156:159], v[52:55], v[108:111], v[156:159]
    v_mfma_f32_16x16x32_bf16 v[168:171], v[60:63], v[104:107], v[168:171]
    v_mfma_f32_16x16x32_bf16 v[172:175], v[60:63], v[108:111], v[172:175]
    s_waitcnt vmcnt(0)
    s_mov_b32 s77, 0
L_vc_18:
    v_bitop3_b32 v9, v64, v68, 1 bitop3:0x80
    v_bitop3_b32 v9, v72, v76, v9 bitop3:0x80
    v_cmp_eq_u32 vcc, 0, v9
    s_add_u32 s77, s77, 1
    s_nop 0
    s_cbranch_vccz L_vd_19
    s_cmp_gt_u32 s77, 20000
    s_cbranch_scc1 L_vd_19
    s_sleep 2
    s_add_u32 s74, s7, 1597440
    buffer_load_dwordx4 v[64:67], v13, s[36:39], s74 offen sc1
    s_add_u32 s74, s7, 1630208
    buffer_load_dwordx4 v[68:71], v13, s[36:39], s74 offen sc1
    s_add_u32 s74, s7, 1863680
    buffer_load_dwordx4 v[72:75], v13, s[36:39], s74 offen sc1
    s_add_u32 s74, s7, 1896448
    buffer_load_dwordx4 v[76:79], v13, s[36:39], s74 offen sc1
    s_waitcnt vmcnt(0)
    s_branch L_vc_18
L_vd_19:
    v_mfma_f32_16x16x32_bf16 v[176:179], v[64:67], v[80:83], 0
    v_sub_f32 v144, v144, v149
    v_add_f32 v148, v148, v145
    v_mfma_f32_16x16x32_bf16 v[180:183], v[64:67], v[84:87], 0
    v_sub_f32 v160, v160, v165
    v_add_f32 v164, v164, v161
    v_mfma_f32_16x16x32_bf16 v[192:195], v[72:75], v[80:83], 0
    v_cvt_pk_bf16_f32 v210, v144, v160
    v_cvt_pk_bf16_f32 v214, v148, v164
    v_mfma_f32_16x16x32_bf16 v[196:199], v[72:75], v[84:87], 0
    v_sub_f32 v146, v146, v151
    v_add_f32 v150, v150, v147
    v_mfma_f32_16x16x32_bf16 v[176:179], v[68:71], v[96:99], v[176:179]
    v_sub_f32 v162, v162, v167
    v_add_f32 v166, v166, v163
    v_mfma_f32_16x16x32_bf16 v[180:183], v[68:71], v[100:103], v[180:183]
    v_cvt_pk_bf16_f32 v226, v146, v162
    v_cvt_pk_bf16_f32 v230, v150, v166
    v_mfma_f32_16x16x32_bf16 v[192:195], v[76:79], v[96:99], v[192:195]
    v_sub_f32 v152, v152, v157
    v_add_f32 v156, v156, v153
    v_mfma_f32_16x16x32_bf16 v[196:199], v[76:79], v[100:103], v[196:199]
    v_sub_f32 v168, v168, v173
    v_add_f32 v172, v172, v169
    v_mfma_f32_16x16x32_bf16 v[184:187], v[64:67], v[88:91], 0
    v_cvt_pk_bf16_f32 v218, v152, v168
    v_cvt_pk_bf16_f32 v222, v156, v172
    v_mfma_f32_16x16x32_bf16 v[188:191], v[64:67], v[92:95], 0
    v_sub_f32 v154, v154, v159
    v_add_f32 v158, v158, v155
    v_mfma_f32_16x16x32_bf16 v[200:203], v[72:75], v[88:91], 0
    v_sub_f32 v170, v170, v175
    v_add_f32 v174, v174, v171
    v_mfma_f32_16x16x32_bf16 v[204:207], v[72:75], v[92:95], 0
    v_cvt_pk_bf16_f32 v234, v154, v170
    v_cvt_pk_bf16_f32 v238, v158, v174
    v_mfma_f32_16x16x32_bf16 v[184:187], v[68:71], v[104:107], v[184:187]
    v_sub_f32 v176, v176, v181
    v_add_f32 v180, v180, v177
    v_mfma_f32_16x16x32_bf16 v[188:191], v[68:71], v[108:111], v[188:191]
    v_sub_f32 v192, v192, v197
    v_add_f32 v196, v196, v193
    v_mfma_f32_16x16x32_bf16 v[200:203], v[76:79], v[104:107], v[200:203]
    v_cvt_pk_bf16_f32 v211, v176, v192
    v_cvt_pk_bf16_f32 v215, v180, v196
    v_mfma_f32_16x16x32_bf16 v[204:207], v[76:79], v[108:111], v[204:207]
    v_sub_f32 v178, v178, v183
    v_add_f32 v182, v182, v179
    v_sub_f32 v194, v194, v199
    v_add_f32 v198, v198, v195
    v_cvt_pk_bf16_f32 v227, v178, v194
    v_cvt_pk_bf16_f32 v231, v182, v198
    v_sub_f32 v184, v184, v189
    v_add_f32 v188, v188, v185
    v_sub_f32 v200, v200, v205
    v_add_f32 v204, v204, v201
    v_cvt_pk_bf16_f32 v219, v184, v200
    v_cvt_pk_bf16_f32 v223, v188, v204
    v_sub_f32 v186, v186, v191
    v_add_f32 v190, v190, v187
    v_sub_f32 v202, v202, v207
    v_add_f32 v206, v206, v203
    v_cvt_pk_bf16_f32 v235, v186, v202
    v_cvt_pk_bf16_f32 v239, v190, v206
    v_mfma_f32_16x16x32_bf16 v[16:19], v[208:211], v[112:115], 0
    v_mfma_f32_16x16x32_bf16 v[16:19], v[212:215], v[116:119], v[16:19]
    v_mfma_f32_16x16x32_bf16 v[24:27], v[208:211], v[120:123], 0
    v_mfma_f32_16x16x32_bf16 v[24:27], v[212:215], v[124:127], v[24:27]
    v_mfma_f32_16x16x32_bf16 v[32:35], v[224:227], v[128:131], 0
    v_mfma_f32_16x16x32_bf16 v[32:35], v[228:231], v[132:135], v[32:35]
    v_mfma_f32_16x16x32_bf16 v[40:43], v[224:227], v[136:139], 0
    v_mfma_f32_16x16x32_bf16 v[40:43], v[228:231], v[140:143], v[40:43]
    s_nop 1
    ds_write_b128 v4, v[16:19] offset:0
    v_mfma_f32_16x16x32_bf16 v[20:23], v[216:219], v[112:115], 0
    v_mfma_f32_16x16x32_bf16 v[20:23], v[220:223], v[116:119], v[20:23]
    ds_write_b128 v4, v[24:27] offset:2048
    v_mfma_f32_16x16x32_bf16 v[28:31], v[216:219], v[120:123], 0
    v_mfma_f32_16x16x32_bf16 v[28:31], v[220:223], v[124:127], v[28:31]
    ds_write_b128 v4, v[32:35] offset:4096
    v_mfma_f32_16x16x32_bf16 v[36:39], v[232:235], v[128:131], 0
    v_mfma_f32_16x16x32_bf16 v[36:39], v[236:239], v[132:135], v[36:39]
    ds_write_b128 v4, v[40:43] offset:6144
    v_mfma_f32_16x16x32_bf16 v[44:47], v[232:235], v[136:139], 0
    v_mfma_f32_16x16x32_bf16 v[44:47], v[236:239], v[140:143], v[44:47]
    ds_write_b128 v5, v[20:23] offset:0
    s_nop 0
    ds_write_b128 v5, v[28:31] offset:2048
    s_nop 1
    ds_write_b128 v5, v[36:39] offset:4096
    s_nop 1
    ds_write_b128 v5, v[44:47] offset:6144
    v_mov_b32 v248, 9
    ds_write_b32 v0, v248 offset:16
    v_bfe_u32 v14, v1, 3, 1
    v_lshlrev_b32 v14, 31, v14
    v_xor_b32 v14, 1.0, v14
    s_mov_b32 s7, 0x49000000
    v_lshlrev_b32 v128, 16, v240
    v_and_b32 v129, s73, v240
    v_lshlrev_b32 v130, 16, v241
    v_and_b32 v131, s73, v241
    v_lshlrev_b32 v132, 16, v242
    v_and_b32 v133, s73, v242
    v_lshlrev_b32 v134, 16, v243
    v_and_b32 v135, s73, v243
    v_lshlrev_b32 v136, 16, v244
    v_and_b32 v137, s73, v244
    v_lshlrev_b32 v138, 16, v245
    v_and_b32 v139, s73, v245
    v_lshlrev_b32 v140, 16, v246
    v_and_b32 v141, s73, v246
    v_lshlrev_b32 v142, 16, v247
    v_and_b32 v143, s73, v247
    ds_read_b32 v248, v8 offset:16
    s_waitcnt lgkmcnt(0)
    v_cmp_gt_u32 vcc, 9, v248
    s_nop 0
    s_cbranch_vccnz L_slow_20
L_back_21:
    ds_read_b128 v[48:51], v11 offset:0
    ds_read_b128 v[52:55], v11 offset:8192
    ds_read_b128 v[56:59], v11 offset:16384
    ds_read_b128 v[60:63], v11 offset:24576
    ds_read_b128 v[64:67], v11 offset:2048
    ds_read_b128 v[68:71], v11 offset:10240
    ds_read_b128 v[72:75], v11 offset:18432
    ds_read_b128 v[76:79], v11 offset:26624
    ds_read_b128 v[80:83], v11 offset:4096
    ds_read_b128 v[84:87], v11 offset:12288
    ds_read_b128 v[88:91], v11 offset:20480
    ds_read_b128 v[92:95], v11 offset:28672
    ds_read_b128 v[96:99], v11 offset:6144
    ds_read_b128 v[100:103], v11 offset:14336
    ds_read_b128 v[104:107], v11 offset:22528
    ds_read_b128 v[108:111], v11 offset:30720
    s_waitcnt lgkmcnt(12)
    v_add_f32 v48, v48, v56
    v_add_f32 v49, v49, v57
    v_add_f32 v50, v50, v58
    v_add_f32 v51, v51, v59
    v_add_f32 v52, v52, v60
    v_add_f32 v53, v53, v61
    v_add_f32 v54, v54, v62
    v_add_f32 v55, v55, v63
    v_fma_f32 v112, v48, v14, v52
    v_fma_f32 v113, v49, v14, v53
    v_fma_f32 v114, v50, v14, v54
    v_fma_f32 v115, v51, v14, v55
    s_waitcnt lgkmcnt(8)
    v_add_f32 v64, v64, v72
    v_add_f32 v65, v65, v73
    v_add_f32 v66, v66, v74
    v_add_f32 v67, v67, v75
    v_add_f32 v68, v68, v76
    v_add_f32 v69, v69, v77
    v_add_f32 v70, v70, v78
    v_add_f32 v71, v71, v79
    v_fma_f32 v116, v64, v14, v68
    v_fma_f32 v117, v65, v14, v69
    v_fma_f32 v118, v66, v14, v70
    v_fma_f32 v119, v67, v14, v71
    s_waitcnt lgkmcnt(4)
    v_add_f32 v80, v80, v88
    v_add_f32 v81, v81, v89
    v_add_f32 v82, v82, v90
    v_add_f32 v83, v83, v91
    v_add_f32 v84, v84, v92
    v_add_f32 v85, v85, v93
    v_add_f32 v86, v86, v94
    v_add_f32 v87, v87, v95
    v_fma_f32 v120, v80, v14, v84
    v_fma_f32 v121, v81, v14, v85
    v_fma_f32 v122, v82, v14, v86
    v_fma_f32 v123, v83, v14, v87
    s_waitcnt lgkmcnt(0)
    v_add_f32 v96, v96, v104
    v_add_f32 v97, v97, v105
    v_add_f32 v98, v98, v106
    v_add_f32 v99, v99, v107
    v_add_f32 v100, v100, v108
    v_add_f32 v101, v101, v109
    v_add_f32 v102, v102, v110
    v_add_f32 v103, v103, v111
    v_fma_f32 v124, v96, v14, v100
    v_fma_f32 v125, v97, v14, v101
    v_fma_f32 v126, v98, v14, v102
    v_fma_f32 v127, v99, v14, v103
    s_setprio 3
    ds_read_b32 v248, v8 offset:32
    s_waitcnt lgkmcnt(0)
    v_cmp_gt_u32 vcc, 19, v248
    s_nop 0
    s_cbranch_vccnz L_slow_22
L_back_23:
    ds_read_b128 v[144:147], v12 offset:0
    ds_read_b128 v[148:151], v12 offset:4096
    ds_read_b128 v[152:155], v12 offset:8192
    ds_read_b128 v[156:159], v12 offset:12288
    s_waitcnt lgkmcnt(2)
    v_add_f32 v144, v144, v148
    v_add_f32 v145, v145, v149
    v_add_f32 v146, v146, v150
    v_add_f32 v147, v147, v151
    s_waitcnt lgkmcnt(1)
    v_add_f32 v144, v144, v152
    v_add_f32 v145, v145, v153
    v_add_f32 v146, v146, v154
    v_add_f32 v147, v147, v155
    s_waitcnt lgkmcnt(0)
    v_add_f32 v144, v144, v156
    v_add_f32 v145, v145, v157
    v_add_f32 v146, v146, v158
    v_add_f32 v147, v147, v159
    v_mul_f32 v160, 0xbfb8aa3b, v144
    v_mul_f32 v161, 0xbfb8aa3b, v145
    v_mul_f32 v162, 0xbfb8aa3b, v146
    v_mul_f32 v163, 0xbfb8aa3b, v147
    v_exp_f32 v160, v160
    v_exp_f32 v161, v161
    v_exp_f32 v162, v162
    v_exp_f32 v163, v163
    v_mul_f32 v144, v144, v112
    v_mul_f32 v145, v145, v113
    v_mul_f32 v146, v146, v114
    v_mul_f32 v147, v147, v115
    v_fma_f32 v160, v160, s7, s7
    v_fma_f32 v161, v161, s7, s7
    v_fma_f32 v162, v162, s7, s7
    v_fma_f32 v163, v163, s7, s7
    v_rcp_f32 v160, v160
    v_rcp_f32 v161, v161
    v_rcp_f32 v162, v162
    v_rcp_f32 v163, v163
    v_fma_f32 v160, v160, v144, v128
    v_fma_f32 v161, v161, v145, v129
    v_fma_f32 v162, v162, v146, v130
    v_fma_f32 v163, v163, v147, v131
    v_cvt_pk_bf16_f32 v176, v160, v161
    v_cvt_pk_bf16_f32 v177, v162, v163
    ds_read_b32 v248, v8 offset:32
    s_waitcnt lgkmcnt(0)
    v_cmp_gt_u32 vcc, 20, v248
    s_nop 0
    s_cbranch_vccnz L_slow_24
L_back_25:
    ds_read_b128 v[144:147], v12 offset:16384
    ds_read_b128 v[148:151], v12 offset:20480
    ds_read_b128 v[152:155], v12 offset:24576
    ds_read_b128 v[156:159], v12 offset:28672
    s_waitcnt lgkmcnt(2)
    v_add_f32 v144, v144, v148
    v_add_f32 v145, v145, v149
    v_add_f32 v146, v146, v150
    v_add_f32 v147, v147, v151
    s_waitcnt lgkmcnt(1)
    v_add_f32 v144, v144, v152
    v_add_f32 v145, v145, v153
    v_add_f32 v146, v146, v154
    v_add_f32 v147, v147, v155
    s_waitcnt lgkmcnt(0)
    v_add_f32 v144, v144, v156
    v_add_f32 v145, v145, v157
    v_add_f32 v146, v146, v158
    v_add_f32 v147, v147, v159
    v_mul_f32 v160, 0xbfb8aa3b, v144
    v_mul_f32 v161, 0xbfb8aa3b, v145
    v_mul_f32 v162, 0xbfb8aa3b, v146
    v_mul_f32 v163, 0xbfb8aa3b, v147
    v_exp_f32 v160, v160
    v_exp_f32 v161, v161
    v_exp_f32 v162, v162
    v_exp_f32 v163, v163
    v_mul_f32 v144, v144, v116
    v_mul_f32 v145, v145, v117
    v_mul_f32 v146, v146, v118
    v_mul_f32 v147, v147, v119
    v_fma_f32 v160, v160, s7, s7
    v_fma_f32 v161, v161, s7, s7
    v_fma_f32 v162, v162, s7, s7
    v_fma_f32 v163, v163, s7, s7
    v_rcp_f32 v160, v160
    v_rcp_f32 v161, v161
    v_rcp_f32 v162, v162
    v_rcp_f32 v163, v163
    v_fma_f32 v160, v160, v144, v132
    v_fma_f32 v161, v161, v145, v133
    v_fma_f32 v162, v162, v146, v134
    v_fma_f32 v163, v163, v147, v135
    v_cvt_pk_bf16_f32 v178, v160, v161
    v_cvt_pk_bf16_f32 v179, v162, v163
    ds_read_b32 v248, v8 offset:32
    s_waitcnt lgkmcnt(0)
    v_cmp_gt_u32 vcc, 21, v248
    s_nop 0
    s_cbranch_vccnz L_slow_26
L_back_27:
    ds_read_b128 v[144:147], v12 offset:32768
    ds_read_b128 v[148:151], v12 offset:36864
    ds_read_b128 v[152:155], v12 offset:40960
    ds_read_b128 v[156:159], v12 offset:45056
    s_waitcnt lgkmcnt(2)
    v_add_f32 v144, v144, v148
    v_add_f32 v145, v145, v149
    v_add_f32 v146, v146, v150
    v_add_f32 v147, v147, v151
    s_waitcnt lgkmcnt(1)
    v_add_f32 v144, v144, v152
    v_add_f32 v145, v145, v153
    v_add_f32 v146, v146, v154
    v_add_f32 v147, v147, v155
    s_waitcnt lgkmcnt(0)
    v_add_f32 v144, v144, v156
    v_add_f32 v145, v145, v157
    v_add_f32 v146, v146, v158
    v_add_f32 v147, v147, v159
    v_mul_f32 v160, 0xbfb8aa3b, v144
    v_mul_f32 v161, 0xbfb8aa3b, v145
    v_mul_f32 v162, 0xbfb8aa3b, v146
    v_mul_f32 v163, 0xbfb8aa3b, v147
    v_exp_f32 v160, v160
    v_exp_f32 v161, v161
    v_exp_f32 v162, v162
    v_exp_f32 v163, v163
    v_mul_f32 v144, v144, v120
    v_mul_f32 v145, v145, v121
    v_mul_f32 v146, v146, v122
    v_mul_f32 v147, v147, v123
    v_fma_f32 v160, v160, s7, s7
    v_fma_f32 v161, v161, s7, s7
    v_fma_f32 v162, v162, s7, s7
    v_fma_f32 v163, v163, s7, s7
    v_rcp_f32 v160, v160
    v_rcp_f32 v161, v161
    v_rcp_f32 v162, v162
    v_rcp_f32 v163, v163
    v_fma_f32 v160, v160, v144, v136
    v_fma_f32 v161, v161, v145, v137
    v_fma_f32 v162, v162, v146, v138
    v_fma_f32 v163, v163, v147, v139
    v_cvt_pk_bf16_f32 v180, v160, v161
    v_cvt_pk_bf16_f32 v181, v162, v163
    buffer_store_dwordx2 v[176:177], v255, s[40:43], s8 offen offset:0 sc1
    buffer_store_dwordx2 v[178:179], v255, s[40:43], s9 offen offset:0 sc1
    buffer_store_dwordx2 v[180:181], v255, s[40:43], s8 offen offset:1024 sc1
    s_barrier
    ds_read_b128 v[144:147], v12 offset:49152
    ds_read_b128 v[148:151], v12 offset:53248
    ds_read_b128 v[152:155], v12 offset:57344
    ds_read_b128 v[156:159], v12 offset:61440
    s_waitcnt lgkmcnt(2)
    v_pk_add_f32 v[144:145], v[144:145], v[148:149]
    v_pk_add_f32 v[146:147], v[146:147], v[150:151]
    s_waitcnt lgkmcnt(1)
    v_pk_add_f32 v[144:145], v[144:145], v[152:153]
    v_pk_add_f32 v[146:147], v[146:147], v[154:155]
    s_waitcnt lgkmcnt(0)
    v_pk_add_f32 v[144:145], v[144:145], v[156:157]
    v_pk_add_f32 v[146:147], v[146:147], v[158:159]
    v_mul_f32 v160, 0xbfb8aa3b, v144
    v_mul_f32 v161, 0xbfb8aa3b, v145
    v_mul_f32 v162, 0xbfb8aa3b, v146
    v_mul_f32 v163, 0xbfb8aa3b, v147
    v_exp_f32 v160, v160
    v_exp_f32 v161, v161
    v_exp_f32 v162, v162
    v_exp_f32 v163, v163
    v_pk_mul_f32 v[144:145], v[144:145], v[124:125]
    v_pk_mul_f32 v[146:147], v[146:147], v[126:127]
    v_fma_f32 v160, v160, s7, s7
    v_fma_f32 v161, v161, s7, s7
    v_fma_f32 v162, v162, s7, s7
    v_fma_f32 v163, v163, s7, s7
    v_rcp_f32 v160, v160
    v_rcp_f32 v161, v161
    v_rcp_f32 v162, v162
    v_rcp_f32 v163, v163
    v_pk_fma_f32 v[160:161], v[160:161], v[144:145], v[140:141]
    v_pk_fma_f32 v[162:163], v[162:163], v[146:147], v[142:143]
    v_cvt_pk_bf16_f32 v182, v160, v161
    v_cvt_pk_bf16_f32 v183, v162, v163
    buffer_store_dwordx2 v[182:183], v255, s[40:43], s9 offen offset:1024 sc1
    s_branch L_final
L_roleY:
    s_cmp_lg_u32 s2, 0
    s_cbranch_scc1 L_nz_28
    s_load_dword s100, s[18:19], 0 glc
    v_mov_b32 v224, 0
    v_mov_b32 v225, 0
    v_mov_b32 v226, 0
    v_mov_b32 v227, 0
    s_lshl_b32 s74, s65, 10
    s_add_u32 s74, s74, 0
    buffer_store_dwordx4 v[224:227], v7, s[36:39], s74 offen sc1
    s_lshl_b32 s74, s65, 10
    s_add_u32 s74, s74, 4096
    buffer_store_dwordx4 v[224:227], v7, s[36:39], s74 offen sc1
    s_lshl_b32 s74, s65, 10
    s_add_u32 s74, s74, 8192
    buffer_store_dwordx4 v[224:227], v7, s[36:39], s74 offen sc1
L_nz_28:
    s_mul_i32 s74, s67, 43
    s_lshr_b32 s71, s74, 3
    s_add_u32 s74, s74, 43
    s_lshr_b32 s74, s74, 3
    s_sub_u32 s72, s74, s71
    v_xor_b32 v248, v248, v249
    v_lshlrev_b32 v248, 4, v248
    v_lshl_or_b32 v5, v249, 8, v248
    s_and_b32 s74, s23, 1
    s_lshl_b32 s74, s74, 7
    s_lshl_b32 s76, s65, 14
    s_add_u32 s74, s74, s76
    v_add_u32 v5, s74, v5
    v_lshrrev_b32 v2, 4, v1
    v_and_b32 v3, 15, v1
    v_mov_b32 v6, 1
    s_lshl2_add_u32 s74, s65, 163776
    v_mov_b32 v0, s74
    v_and_b32 v8, 3, v1
    v_lshlrev_b32 v8, 2, v8
    v_add_u32 v8, 163776, v8
    s_mov_b32 s28, s12
    s_mov_b32 s29, s13
    s_mov_b32 s30, 1409024
    s_mov_b32 s31, 0x20000
    s_mov_b32 s44, s18
    s_mov_b32 s45, s19
    s_mov_b32 s46, 256
    s_mov_b32 s47, 0x20000
    s_mul_i32 s74, s67, 176128
    s_add_u32 s74, s74, 5242880
    s_add_u32 s56, s20, s74
    s_addc_u32 s57, s21, 0
    s_mov_b32 s58, 176128
    s_mov_b32 s59, 0x20000
    v_mov_b32 v13, 163776
    s_mul_i32 s5, s65, 3072
    s_lshl_b32 s16, s71, 6
    s_and_b32 s74, s65, 1
    s_lshl_b32 s74, s74, 4
    s_and_b32 s75, s65, 2
    s_lshl1_add_u32 s74, s75, s74
    s_mul_i32 s74, s74, 2752
    s_add_u32 s16, s16, s74
    s_lshl_b32 s75, s72, 2
    s_sub_u32 s75, s75, 16
    v_lshrrev_b32 v240, 5, v1
    v_bfe_u32 v241, v1, 3, 2
    v_lshl_or_b32 v240, v240, 3, v241
    v_mul_u32_u24 v240, 2752, v240
    v_and_b32 v241, 7, v1
    v_lshlrev_b32 v242, 1, v2
    v_xor_b32 v241, v241, v242
    v_cmp_gt_u32 vcc, s75, v241
    v_lshl_add_u32 v158, v241, 4, v240
    s_nop 0
    v_cndmask_b32 v159, 2.0, v158, vcc
    s_cmp_ge_u32 s65, 2
    s_cselect_b32 s48, s8, s6
    s_cselect_b32 s49, s9, s7
    s_mov_b32 s50, 1052672
    s_mov_b32 s51, 0x20000
    s_mul_i32 s17, s66, 514
    s_add_u32 s17, s17, 2
    s_and_b32 s17, s17, -16
    s_lshl_b32 s75, s67, 6
    s_add_u32 s17, s17, s75
    s_and_b32 s75, s65, 1
    s_mul_i32 s75, s75, 526336
    s_add_u32 s17, s17, s75
    v_add_u32 v240, 0, v1
    v_mul_u32_u24 v241, 52429, v240
    v_lshrrev_b32 v241, 18, v241
    v_mul_u32_u24 v241, 16368, v241
    v_add_u32 v173, v241, v7
    v_add_u32 v240, 64, v1
    v_mul_u32_u24 v241, 52429, v240
    v_lshrrev_b32 v241, 18, v241
    v_mul_u32_u24 v241, 16368, v241
    v_add_u32 v174, v241, v7
    v_add_u32 v240, 128, v1
    v_mul_u32_u24 v241, 52429, v240
    v_lshrrev_b32 v241, 18, v241
    v_mul_u32_u24 v241, 16368, v241
    v_add_u32 v175, v241, v7
    s_lshr_b32 s12, s65, 1
    s_lshl1_add_u32 s12, s66, s12
    s_and_b32 s13, s65, 1
    s_lshl_b32 s13, s13, 4
    v_add_u32 v148, s13, v3
    v_cvt_f32_u32 v148, v148
    v_mul_f32 v157, 0x3d000000, v148
    v_lshl_add_u32 v149, v2, 8, s12
    v_cvt_f32_u32 v149, v149
    v_mul_f32 v149, 0x3a000000, v149
    v_mul_f32 v156, v148, v149
    v_mov_b32 v150, v156
    v_fmamk_f32 v151, v157, 0x3f800000, v156
    v_cos_f32 v152, v150
    v_cos_f32 v153, v151
    v_sin_f32 v154, v150
    v_sin_f32 v155, v151
    v_fmamk_f32 v150, v157, 0x40000000, v156
    v_fmamk_f32 v151, v157, 0x40400000, v156
    v_cvt_pk_bf16_f32 v184, v152, v153
    v_cvt_pk_bf16_f32 v188, v154, v155
    v_cos_f32 v152, v150
    v_cos_f32 v153, v151
    v_sin_f32 v154, v150
    v_sin_f32 v155, v151
    v_fmamk_f32 v150, v157, 0x41800000, v156
    v_fmamk_f32 v151, v157, 0x41880000, v156
    v_cvt_pk_bf16_f32 v185, v152, v153
    v_cvt_pk_bf16_f32 v189, v154, v155
    v_cos_f32 v152, v150
    v_cos_f32 v153, v151
    v_sin_f32 v154, v150
    v_sin_f32 v155, v151
    v_fmamk_f32 v150, v157, 0x41900000, v156
    v_fmamk_f32 v151, v157, 0x41980000, v156
    v_cvt_pk_bf16_f32 v186, v152, v153
    v_cvt_pk_bf16_f32 v190, v154, v155
    v_cos_f32 v152, v150
    v_cos_f32 v153, v151
    v_sin_f32 v154, v150
    v_sin_f32 v155, v151
    v_cvt_pk_bf16_f32 v187, v152, v153
    v_cvt_pk_bf16_f32 v191, v154, v155
    s_lshl_b32 s12, s65, 11
    s_add_u32 s12, s12, 139264
    v_add_u32 v148, s12, v7
    ds_write_b128 v148, v[184:187]
    ds_write_b128 v148, v[188:191] offset:1024
    s_add_u32 s77, s68, 2
    s_and_b32 s77, s77, 7
    s_lshl_b32 s77, s77, 7
    s_add_u32 s77, s77, s22
    buffer_load_dwordx4 v[88:91], v4, s[24:27], s77 offen offset:0
    s_nop 0
    buffer_load_dwordx4 v[92:95], v4, s[24:27], s77 offen offset:128
    s_add_u32 s77, s68, 4
    s_and_b32 s77, s77, 7
    s_lshl_b32 s77, s77, 7
    s_add_u32 s77, s77, s22
    buffer_load_dwordx4 v[96:99], v4, s[24:27], s77 offen offset:0
    s_nop 0
    buffer_load_dwordx4 v[100:103], v4, s[24:27], s77 offen offset:128
    s_add_u32 s77, s68, 6
    s_and_b32 s77, s77, 7
    s_lshl_b32 s77, s77, 7
    s_add_u32 s77, s77, s22
    buffer_load_dwordx4 v[104:107], v4, s[24:27], s77 offen offset:0
    s_nop 0
    buffer_load_dwordx4 v[108:111], v4, s[24:27], s77 offen offset:128
    s_barrier
    s_mov_b32 s32, s14
    s_mov_b32 s33, s15
    s_mov_b32 s34, 1409024
    s_mov_b32 s35, 0x20000
    s_lshl_b32 s74, s67, 2
    s_lshr_b32 s74, 0x74632510, s74
    s_and_b32 s74, s74, 7
    s_lshl_b32 s74, s74, 5
    s_add_u32 s73, s74, s66
    s_mul_i32 s15, s65, 3072
    s_add_u32 s15, s15, 126976
    v_lshrrev_b32 v240, 2, v1
    v_and_b32 v241, 3, v1
    v_lshlrev_b32 v172, 10, v240
    v_lshl_or_b32 v172, v241, 4, v172
    v_lshlrev_b32 v12, 6, v240
    v_lshl_or_b32 v12, v241, 3, v12
    v_add_u32 v12, s15, v12
    s_lshr_b32 s74, s73, 2
    s_lshl_b32 s74, s74, 15
    s_and_b32 s75, s73, 3
    s_lshl_b32 s75, s75, 7
    s_add_u32 s74, s74, s75
    s_mul_i32 s75, s65, 0x140
    s_and_b32 s75, s75, 0x240
    s_add_u32 s74, s74, s75
    s_mov_b32 m0, s15
    s_nop 0
    buffer_load_dwordx4 v172, s[32:35], s74 offen lds
    s_add_u32 s74, s74, 15360
    buffer_load_dwordx4 v172, s[32:35], s74 offen offset:1024 lds
    buffer_load_dwordx4 v[128:131], v173, s[48:51], s17 offen offset:0
    buffer_load_dwordx4 v[132:135], v174, s[48:51], s17 offen offset:1024
    s_mov_b32 exec_hi, 0
    buffer_load_dwordx4 v[136:139], v175, s[48:51], s17 offen offset:2048
    s_mov_b32 exec_hi, -1
    s_cmp_lg_u32 s2, 0
    s_cbranch_scc1 L_nz_29
    s_waitcnt vmcnt(11)
    s_atomic_add s10, s[18:19], 0
L_nz_29:
    s_setprio 2
    v_mov_b32 v200, 0
    v_mov_b32 v201, 0
    v_mov_b32 v202, 0
    v_mov_b32 v203, 0
    s_mov_b32 s11, 0x3f803f80
    s_waitcnt vmcnt(13)
    v_dot2c_f32_bf16 v200, s11, v80
    v_dot2c_f32_bf16 v202, v80, v80
    v_dot2c_f32_bf16 v201, s11, v81
    v_dot2c_f32_bf16 v203, v81, v81
    v_dot2c_f32_bf16 v200, s11, v82
    v_dot2c_f32_bf16 v202, v82, v82
    v_dot2c_f32_bf16 v201, s11, v83
    v_dot2c_f32_bf16 v203, v83, v83
    s_waitcnt vmcnt(12)
    v_dot2c_f32_bf16 v200, s11, v84
    v_dot2c_f32_bf16 v202, v84, v84
    v_dot2c_f32_bf16 v201, s11, v85
    v_dot2c_f32_bf16 v203, v85, v85
    v_dot2c_f32_bf16 v200, s11, v86
    v_dot2c_f32_bf16 v202, v86, v86
    v_dot2c_f32_bf16 v201, s11, v87
    v_dot2c_f32_bf16 v203, v87, v87
    s_waitcnt vmcnt(10)
    v_dot2c_f32_bf16 v200, s11, v88
    v_dot2c_f32_bf16 v202, v88, v88
    v_dot2c_f32_bf16 v201, s11, v89
    v_dot2c_f32_bf16 v203, v89, v89
    v_dot2c_f32_bf16 v200, s11, v90
    v_dot2c_f32_bf16 v202, v90, v90
    v_dot2c_f32_bf16 v201, s11, v91
    v_dot2c_f32_bf16 v203, v91, v91
    s_waitcnt vmcnt(9)
    v_dot2c_f32_bf16 v200, s11, v92
    v_dot2c_f32_bf16 v202, v92, v92
    v_dot2c_f32_bf16 v201, s11, v93
    v_dot2c_f32_bf16 v203, v93, v93
    v_dot2c_f32_bf16 v200, s11, v94
    v_dot2c_f32_bf16 v202, v94, v94
    v_dot2c_f32_bf16 v201, s11, v95
    v_dot2c_f32_bf16 v203, v95, v95
    s_waitcnt vmcnt(8)
    v_dot2c_f32_bf16 v200, s11, v96
    v_dot2c_f32_bf16 v202, v96, v96
    v_dot2c_f32_bf16 v201, s11, v97
    v_dot2c_f32_bf16 v203, v97, v97
    v_dot2c_f32_bf16 v200, s11, v98
    v_dot2c_f32_bf16 v202, v98, v98
    v_dot2c_f32_bf16 v201, s11, v99
    v_dot2c_f32_bf16 v203, v99, v99
    s_waitcnt vmcnt(7)
    v_dot2c_f32_bf16 v200, s11, v100
    v_dot2c_f32_bf16 v202, v100, v100
    v_dot2c_f32_bf16 v201, s11, v101
    v_dot2c_f32_bf16 v203, v101, v101
    v_dot2c_f32_bf16 v200, s11, v102
    v_dot2c_f32_bf16 v202, v102, v102
    v_dot2c_f32_bf16 v201, s11, v103
    v_dot2c_f32_bf16 v203, v103, v103
    s_waitcnt vmcnt(6)
    v_dot2c_f32_bf16 v200, s11, v104
    v_dot2c_f32_bf16 v202, v104, v104
    v_dot2c_f32_bf16 v201, s11, v105
    v_dot2c_f32_bf16 v203, v105, v105
    v_dot2c_f32_bf16 v200, s11, v106
    v_dot2c_f32_bf16 v202, v106, v106
    v_dot2c_f32_bf16 v201, s11, v107
    v_dot2c_f32_bf16 v203, v107, v107
    s_waitcnt vmcnt(5)
    v_dot2c_f32_bf16 v200, s11, v108
    v_dot2c_f32_bf16 v202, v108, v108
    v_dot2c_f32_bf16 v201, s11, v109
    v_dot2c_f32_bf16 v203, v109, v109
    v_dot2c_f32_bf16 v200, s11, v110
    v_dot2c_f32_bf16 v202, v110, v110
    v_dot2c_f32_bf16 v201, s11, v111
    v_dot2c_f32_bf16 v203, v111, v111
    s_nop 1
    v_add_f32 v200, v200, v201
    v_add_f32 v202, v202, v203
    s_nop 0
    v_add_f32_dpp v200, v200, v200 quad_perm:[1,0,3,2] row_mask:0xf bank_mask:0xf
    v_add_f32_dpp v202, v202, v202 quad_perm:[1,0,3,2] row_mask:0xf bank_mask:0xf
    s_nop 0
    v_add_f32_dpp v200, v200, v200 quad_perm:[2,3,0,1] row_mask:0xf bank_mask:0xf
    v_add_f32_dpp v202, v202, v202 quad_perm:[2,3,0,1] row_mask:0xf bank_mask:0xf
    s_nop 0
    v_add_f32_dpp v200, v200, v200 row_half_mirror row_mask:0xf bank_mask:0xf
    v_add_f32_dpp v202, v202, v202 row_half_mirror row_mask:0xf bank_mask:0xf
    v_mul_f32 v200, 0xbb000000, v200
    v_mul_f32 v202, 0x3b000000, v202
    v_fma_f32 v202, -v200, v200, v202
    v_max_f32 v202, 0, v202
    v_add_f32 v202, 0x3727c5ac, v202
    v_rsq_f32 v202, v202
    s_nop 0
    v_cvt_pk_bf16_f32 v204, v202, 0
    v_lshlrev_b32 v205, 16, v204
    v_mul_f32 v206, v200, v205
    v_dot2_f32_bf16 v112, v80, v204, v206
    v_dot2_f32_bf16 v113, v80, v205, v206
    v_dot2_f32_bf16 v114, v81, v204, v206
    v_dot2_f32_bf16 v115, v81, v205, v206
    v_dot2_f32_bf16 v116, v82, v204, v206
    v_dot2_f32_bf16 v117, v82, v205, v206
    v_dot2_f32_bf16 v118, v83, v204, v206
    v_dot2_f32_bf16 v119, v83, v205, v206
    v_dot2_f32_bf16 v120, v84, v204, v206
    v_dot2_f32_bf16 v121, v84, v205, v206
    v_dot2_f32_bf16 v122, v85, v204, v206
    v_dot2_f32_bf16 v123, v85, v205, v206
    v_dot2_f32_bf16 v124, v86, v204, v206
    v_dot2_f32_bf16 v125, v86, v205, v206
    v_dot2_f32_bf16 v126, v87, v204, v206
    v_dot2_f32_bf16 v127, v87, v205, v206
    v_cvt_pk_bf16_f32 v80, v112, v113
    v_cvt_pk_bf16_f32 v81, v114, v115
    v_cvt_pk_bf16_f32 v82, v116, v117
    v_cvt_pk_bf16_f32 v83, v118, v119
    ds_write_b128 v5, v[80:83] offset:0
    v_dot2_f32_bf16 v112, v88, v204, v206
    v_dot2_f32_bf16 v113, v88, v205, v206
    v_dot2_f32_bf16 v114, v89, v204, v206
    v_dot2_f32_bf16 v115, v89, v205, v206
    v_dot2_f32_bf16 v116, v90, v204, v206
    v_dot2_f32_bf16 v117, v90, v205, v206
    v_dot2_f32_bf16 v118, v91, v204, v206
    v_dot2_f32_bf16 v119, v91, v205, v206
    v_cvt_pk_bf16_f32 v84, v120, v121
    v_cvt_pk_bf16_f32 v85, v122, v123
    v_cvt_pk_bf16_f32 v86, v124, v125
    v_cvt_pk_bf16_f32 v87, v126, v127
    ds_write_b128 v5, v[84:87] offset:2048
    v_dot2_f32_bf16 v120, v92, v204, v206
    v_dot2_f32_bf16 v121, v92, v205, v206
    v_dot2_f32_bf16 v122, v93, v204, v206
    v_dot2_f32_bf16 v123, v93, v205, v206
    v_dot2_f32_bf16 v124, v94, v204, v206
    v_dot2_f32_bf16 v125, v94, v205, v206
    v_dot2_f32_bf16 v126, v95, v204, v206
    v_dot2_f32_bf16 v127, v95, v205, v206
    v_cvt_pk_bf16_f32 v88, v112, v113
    v_cvt_pk_bf16_f32 v89, v114, v115
    v_cvt_pk_bf16_f32 v90, v116, v117
    v_cvt_pk_bf16_f32 v91, v118, v119
    ds_write_b128 v5, v[88:91] offset:4096
    v_dot2_f32_bf16 v112, v96, v204, v206
    v_dot2_f32_bf16 v113, v96, v205, v206
    v_dot2_f32_bf16 v114, v97, v204, v206
    v_dot2_f32_bf16 v115, v97, v205, v206
    v_dot2_f32_bf16 v116, v98, v204, v206
    v_dot2_f32_bf16 v117, v98, v205, v206
    v_dot2_f32_bf16 v118, v99, v204, v206
    v_dot2_f32_bf16 v119, v99, v205, v206
    v_cvt_pk_bf16_f32 v92, v120, v121
    v_cvt_pk_bf16_f32 v93, v122, v123
    v_cvt_pk_bf16_f32 v94, v124, v125
    v_cvt_pk_bf16_f32 v95, v126, v127
    ds_write_b128 v5, v[92:95] offset:6144
    v_dot2_f32_bf16 v120, v100, v204, v206
    v_dot2_f32_bf16 v121, v100, v205, v206
    v_dot2_f32_bf16 v122, v101, v204, v206
    v_dot2_f32_bf16 v123, v101, v205, v206
    v_dot2_f32_bf16 v124, v102, v204, v206
    v_dot2_f32_bf16 v125, v102, v205, v206
    v_dot2_f32_bf16 v126, v103, v204, v206
    v_dot2_f32_bf16 v127, v103, v205, v206
    v_cvt_pk_bf16_f32 v96, v112, v113
    v_cvt_pk_bf16_f32 v97, v114, v115
    v_cvt_pk_bf16_f32 v98, v116, v117
    v_cvt_pk_bf16_f32 v99, v118, v119
    ds_write_b128 v5, v[96:99] offset:8192
    v_dot2_f32_bf16 v112, v104, v204, v206
    v_dot2_f32_bf16 v113, v104, v205, v206
    v_dot2_f32_bf16 v114, v105, v204, v206
    v_dot2_f32_bf16 v115, v105, v205, v206
    v_dot2_f32_bf16 v116, v106, v204, v206
    v_dot2_f32_bf16 v117, v106, v205, v206
    v_dot2_f32_bf16 v118, v107, v204, v206
    v_dot2_f32_bf16 v119, v107, v205, v206
    v_cvt_pk_bf16_f32 v100, v120, v121
    v_cvt_pk_bf16_f32 v101, v122, v123
    v_cvt_pk_bf16_f32 v102, v124, v125
    v_cvt_pk_bf16_f32 v103, v126, v127
    ds_write_b128 v5, v[100:103] offset:10240
    v_dot2_f32_bf16 v120, v108, v204, v206
    v_dot2_f32_bf16 v121, v108, v205, v206
    v_dot2_f32_bf16 v122, v109, v204, v206
    v_dot2_f32_bf16 v123, v109, v205, v206
    v_dot2_f32_bf16 v124, v110, v204, v206
    v_dot2_f32_bf16 v125, v110, v205, v206
    v_dot2_f32_bf16 v126, v111, v204, v206
    v_dot2_f32_bf16 v127, v111, v205, v206
    v_cvt_pk_bf16_f32 v104, v112, v113
    v_cvt_pk_bf16_f32 v105, v114, v115
    v_cvt_pk_bf16_f32 v106, v116, v117
    v_cvt_pk_bf16_f32 v107, v118, v119
    ds_write_b128 v5, v[104:107] offset:12288
    v_cvt_pk_bf16_f32 v108, v120, v121
    v_cvt_pk_bf16_f32 v109, v122, v123
    v_cvt_pk_bf16_f32 v110, v124, v125
    v_cvt_pk_bf16_f32 v111, v126, v127
    ds_write_b128 v5, v[108:111] offset:14336
    s_waitcnt vmcnt(3)
    ds_read_b64_tr_b16 v[176:177], v12 offset:0
    ds_read_b64_tr_b16 v[178:179], v12 offset:1024
    ds_read_b64_tr_b16 v[180:181], v12 offset:32
    ds_read_b64_tr_b16 v[182:183], v12 offset:1056
    s_and_b32 s74, s73, 3
    s_and_b32 s75, s65, 1
    s_lshl1_add_u32 s74, s74, s75
    s_mul_i32 s74, s74, 176128
    s_and_b32 s75, s73, -4
    s_and_b32 s77, s65, 2
    s_add_u32 s75, s75, s77
    s_lshl_b32 s75, s75, 10
    s_add_u32 s74, s74, s75
    s_add_u32 s74, s74, 5242880
    s_cmp_lt_u32 s73, 172
    s_cselect_b32 s74, s74, 16777216
    s_waitcnt lgkmcnt(0)
    buffer_store_dwordx4 v[176:179], v7, s[36:39], s74 offen offset:0 sc1
    buffer_store_dwordx4 v[180:183], v7, s[36:39], s74 offen offset:1024 sc1
    s_waitcnt lgkmcnt(0)
    s_barrier
    s_setprio 2
    s_lshl_b32 s74, s65, 8
    buffer_load_dword v160, off, s[44:47], s74 sc1
    s_lshl1_add_u32 s74, s68, 0
    s_and_b32 s74, s74, 15
    s_mul_i32 s74, s74, 88064
    s_add_u32 m0, s5, 65536
    s_add_u32 s74, s74, s16
    buffer_load_dwordx4 v158, s[28:31], s74 offen offset:0 lds
    s_add_u32 m0, s5, 66432
    s_nop 0
    buffer_load_dwordx4 v158, s[28:31], s74 offen offset:128 lds
    s_add_u32 m0, s5, 67328
    s_nop 0
    buffer_load_dwordx4 v159, s[28:31], s74 offen offset:256 lds
    s_lshl1_add_u32 s74, s68, 1
    s_and_b32 s74, s74, 15
    s_mul_i32 s74, s74, 88064
    s_add_u32 m0, s5, 77824
    s_add_u32 s74, s74, s16
    buffer_load_dwordx4 v158, s[28:31], s74 offen offset:0 lds
    s_add_u32 m0, s5, 78720
    s_nop 0
    buffer_load_dwordx4 v158, s[28:31], s74 offen offset:128 lds
    s_add_u32 m0, s5, 79616
    s_nop 0
    buffer_load_dwordx4 v159, s[28:31], s74 offen offset:256 lds
    s_lshl1_add_u32 s74, s68, 2
    s_and_b32 s74, s74, 15
    s_mul_i32 s74, s74, 88064
    s_add_u32 m0, s5, 90112
    s_add_u32 s74, s74, s16
    buffer_load_dwordx4 v158, s[28:31], s74 offen offset:0 lds
    s_add_u32 m0, s5, 91008
    s_nop 0
    buffer_load_dwordx4 v158, s[28:31], s74 offen offset:128 lds
    s_add_u32 m0, s5, 91904
    s_nop 0
    buffer_load_dwordx4 v159, s[28:31], s74 offen offset:256 lds
    v_lshrrev_b32 v11, 2, v1
    v_lshlrev_b32 v11, 8, v11
    v_and_b32 v240, 3, v1
    v_lshl_or_b32 v11, v240, 4, v11
    s_mul_i32 s4, s66, 66560
    s_lshl_b32 s74, s67, 13
    s_add_u32 s4, s4, s74
    s_mul_i32 s74, s65, 0xa0
    s_and_b32 s74, s74, 0xc0
    s_add_u32 s4, s4, s74
    s_add_u32 s4, s4, 2097152
    s_lshl1_add_u32 s74, s68, 3
    s_and_b32 s74, s74, 15
    s_mul_i32 s74, s74, 88064
    s_add_u32 m0, s5, 102400
    s_add_u32 s74, s74, s16
    buffer_load_dwordx4 v158, s[28:31], s74 offen offset:0 lds
    s_add_u32 m0, s5, 103296
    s_nop 0
    buffer_load_dwordx4 v158, s[28:31], s74 offen offset:128 lds
    s_add_u32 m0, s5, 104192
    s_nop 0
    buffer_load_dwordx4 v159, s[28:31], s74 offen offset:256 lds
    v_lshlrev_b32 v147, 9, v2
    v_lshl_or_b32 v147, v3, 2, v147
    s_lshl_b32 s12, s65, 12
    s_add_u32 s12, s12, 24576
    v_lshlrev_b32 v144, 5, v3
    v_lshl_or_b32 v144, v2, 3, v144
    v_add_u32 v144, s12, v144
    v_add_u32 v145, s12, v7
    s_mul_i32 s12, s66, 176128
    s_add_u32 s12, s12, 7340032
    s_mov_b32 s54, 176128
    s_mov_b32 s55, 0x20000
    s_add_u32 s52, s20, s12
    s_addc_u32 s53, s21, 0
    s_sub_u32 s12, s65, s71
    s_and_b32 s12, s12, 3
    s_add_u32 s12, s12, s71
    s_lshl_b32 s24, s12, 12
    s_lshl_b32 s12, s65, 12
    s_lshl1_add_u32 s74, s68, 4
    s_and_b32 s74, s74, 15
    s_mul_i32 s74, s74, 88064
    s_add_u32 m0, s5, 114688
    s_add_u32 s74, s74, s16
    buffer_load_dwordx4 v158, s[28:31], s74 offen offset:0 lds
    s_add_u32 m0, s5, 115584
    s_nop 0
    buffer_load_dwordx4 v158, s[28:31], s74 offen offset:128 lds
    s_add_u32 m0, s5, 116480
    s_nop 0
    buffer_load_dwordx4 v159, s[28:31], s74 offen offset:256 lds
    s_add_u32 s25, s12, 0
    s_cmp_ge_u32 s25, s24
    s_cselect_b32 s13, 16384, 0
    s_add_u32 s25, s25, s13
    s_add_u32 s26, s12, 16384
    s_cmp_ge_u32 s26, s24
    s_cselect_b32 s13, 16384, 0
    s_add_u32 s26, s26, s13
    s_add_u32 s27, s12, 32768
    s_cmp_ge_u32 s27, s24
    s_cselect_b32 s13, 16384, 0
    s_add_u32 s27, s27, s13
    s_add_u32 s32, s12, 49152
    s_cmp_ge_u32 s32, s24
    s_cselect_b32 s13, 16384, 0
    s_add_u32 s32, s32, s13
    s_add_u32 s33, s12, 65536
    s_cmp_ge_u32 s33, s24
    s_cselect_b32 s13, 16384, 0
    s_add_u32 s33, s33, s13
    s_add_u32 s34, s12, 81920
    s_cmp_ge_u32 s34, s24
    s_cselect_b32 s13, 16384, 0
    s_add_u32 s34, s34, s13
    s_add_u32 s35, s12, 98304
    s_cmp_ge_u32 s35, s24
    s_cselect_b32 s13, 16384, 0
    s_add_u32 s35, s35, s13
    s_lshl1_add_u32 s74, s68, 5
    s_and_b32 s74, s74, 15
    s_mul_i32 s74, s74, 88064
    s_add_u32 m0, s5, 126976
    s_add_u32 s74, s74, s16
    buffer_load_dwordx4 v158, s[28:31], s74 offen offset:0 lds
    s_add_u32 m0, s5, 127872
    s_nop 0
    buffer_load_dwordx4 v158, s[28:31], s74 offen offset:128 lds
    s_add_u32 m0, s5, 128768
    s_nop 0
    buffer_load_dwordx4 v159, s[28:31], s74 offen offset:256 lds
    s_waitcnt vmcnt(18)
    s_cmp_lg_u32 s64, 4
    s_cbranch_scc1 L_y0_30
    s_mov_b32 s77, 0
    s_branch L_ck_32
L_sp_31:
    buffer_load_dword v160, off, s[44:47], 0 sc1
    s_waitcnt vmcnt(0)
L_ck_32:
    v_cmp_gt_u32 vcc, 4, v160
    s_add_u32 s77, s77, 1
    s_nop 0
    s_cbranch_vccz L_dn_33
    s_cmp_gt_u32 s77, 30000
    s_cbranch_scc1 L_dn_33
    s_sleep 2
    s_branch L_sp_31
L_dn_33:
L_y0_30:
    s_waitcnt vmcnt(9)
    s_barrier
    s_and_b32 s74, s73, 3
    s_lshl2_add_u32 s74, s74, s65
    s_lshl_b32 s74, s74, 8
    s_add_u32 s74, s74, 0
    s_add_u32 s75, s74, 128
    s_cmp_ge_u32 s73, 172
    s_cbranch_scc1 L_nw_34
    s_atomic_add s10, s[20:21], s74
    s_atomic_add s10, s[20:21], s75
L_nw_34:
    s_lshl1_add_u32 s74, s68, 6
    s_and_b32 s74, s74, 15
    s_mul_i32 s74, s74, 88064
    s_add_u32 m0, s5, 139264
    s_add_u32 s74, s74, s16
    buffer_load_dwordx4 v158, s[28:31], s74 offen offset:0 lds
    s_add_u32 m0, s5, 140160
    s_nop 0
    buffer_load_dwordx4 v158, s[28:31], s74 offen offset:128 lds
    s_add_u32 m0, s5, 141056
    s_nop 0
    buffer_load_dwordx4 v159, s[28:31], s74 offen offset:256 lds
    s_add_u32 s40, s12, 114688
    s_cmp_ge_u32 s40, s24
    s_cselect_b32 s13, 16384, 0
    s_add_u32 s40, s40, s13
    s_add_u32 s41, s12, 131072
    s_cmp_ge_u32 s41, s24
    s_cselect_b32 s13, 16384, 0
    s_add_u32 s41, s41, s13
    s_add_u32 s42, s12, 147456
    s_cmp_ge_u32 s42, s24
    s_cselect_b32 s13, 16384, 0
    s_add_u32 s42, s42, s13
    v_add_u32 v152, 0, v3
    v_cvt_f32_u32 v152, v152
    v_mul_f32 v151, 0x3c800000, v152
    v_cvt_f32_u32 v153, v2
    v_mul_f32 v153, 4.0, v153
    v_mul_f32 v150, v151, v153
    v_mov_b32 v152, v150
    v_fmamk_f32 v153, v151, 0x3f800000, v150
    v_cos_f32 v154, v152
    v_cos_f32 v155, v153
    s_lshl1_add_u32 s74, s68, 7
    s_and_b32 s74, s74, 15
    s_mul_i32 s74, s74, 88064
    s_add_u32 m0, s5, 0
    s_add_u32 s74, s74, s16
    buffer_load_dwordx4 v158, s[28:31], s74 offen offset:0 lds
    s_add_u32 m0, s5, 896
    s_nop 0
    buffer_load_dwordx4 v158, s[28:31], s74 offen offset:128 lds
    s_add_u32 m0, s5, 1792
    s_nop 0
    buffer_load_dwordx4 v159, s[28:31], s74 offen offset:256 lds
    v_sin_f32 v156, v152
    v_sin_f32 v157, v153
    v_fmamk_f32 v152, v151, 0x40000000, v150
    v_fmamk_f32 v153, v151, 0x40400000, v150
    v_cvt_pk_bf16_f32 v16, v154, v155
    v_cvt_pk_bf16_f32 v48, v156, v157
    v_cos_f32 v154, v152
    v_cos_f32 v155, v153
    v_sin_f32 v156, v152
    v_sin_f32 v157, v153
    v_fmamk_f32 v152, v151, 0x41800000, v150
    v_fmamk_f32 v153, v151, 0x41880000, v150
    v_cvt_pk_bf16_f32 v17, v154, v155
    v_cvt_pk_bf16_f32 v49, v156, v157
    s_lshl1_add_u32 s74, s68, 8
    s_and_b32 s74, s74, 15
    s_mul_i32 s74, s74, 88064
    s_add_u32 m0, s5, 12288
    s_add_u32 s74, s74, s16
    buffer_load_dwordx4 v158, s[28:31], s74 offen offset:0 lds
    s_add_u32 m0, s5, 13184
    s_nop 0
    buffer_load_dwordx4 v158, s[28:31], s74 offen offset:128 lds
    s_add_u32 m0, s5, 14080
    s_nop 0
    buffer_load_dwordx4 v159, s[28:31], s74 offen offset:256 lds
    v_cos_f32 v154, v152
    v_cos_f32 v155, v153
    v_sin_f32 v156, v152
    v_sin_f32 v157, v153
    v_fmamk_f32 v152, v151, 0x41900000, v150
    v_fmamk_f32 v153, v151, 0x41980000, v150
    v_cvt_pk_bf16_f32 v18, v154, v155
    v_cvt_pk_bf16_f32 v50, v156, v157
    v_cos_f32 v154, v152
    v_cos_f32 v155, v153
    v_sin_f32 v156, v152
    v_sin_f32 v157, v153
    s_lshl1_add_u32 s74, s68, 9
    s_and_b32 s74, s74, 15
    s_mul_i32 s74, s74, 88064
    s_add_u32 m0, s5, 24576
    s_add_u32 s74, s74, s16
    buffer_load_dwordx4 v158, s[28:31], s74 offen offset:0 lds
    s_add_u32 m0, s5, 25472
    s_nop 0
    buffer_load_dwordx4 v158, s[28:31], s74 offen offset:128 lds
    s_add_u32 m0, s5, 26368
    s_nop 0
    buffer_load_dwordx4 v159, s[28:31], s74 offen offset:256 lds
    v_cvt_pk_bf16_f32 v19, v154, v155
    v_cvt_pk_bf16_f32 v51, v156, v157
    v_add_u32 v152, 16, v3
    v_cvt_f32_u32 v152, v152
    v_mul_f32 v151, 0x3c800000, v152
    v_cvt_f32_u32 v153, v2
    v_mul_f32 v153, 4.0, v153
    v_mul_f32 v150, v151, v153
    v_mov_b32 v152, v150
    v_fmamk_f32 v153, v151, 0x3f800000, v150
    v_cos_f32 v154, v152
    v_cos_f32 v155, v153
    v_sin_f32 v156, v152
    v_sin_f32 v157, v153
    v_fmamk_f32 v152, v151, 0x40000000, v150
    v_fmamk_f32 v153, v151, 0x40400000, v150
    v_cvt_pk_bf16_f32 v24, v154, v155
    v_cvt_pk_bf16_f32 v56, v156, v157
    v_cos_f32 v154, v152
    v_cos_f32 v155, v153
    v_sin_f32 v156, v152
    v_sin_f32 v157, v153
    v_fmamk_f32 v152, v151, 0x41800000, v150
    v_fmamk_f32 v153, v151, 0x41880000, v150
    v_cvt_pk_bf16_f32 v25, v154, v155
    v_cvt_pk_bf16_f32 v57, v156, v157
    v_cos_f32 v154, v152
    v_cos_f32 v155, v153
    v_sin_f32 v156, v152
    s_waitcnt vmcnt(9)
    s_barrier
    v_and_b32 v162, 6, v1
    v_xor_b32 v162, v162, v2
    v_and_b32 v163, 3, v1
    v_lshl_or_b32 v162, v163, 3, v162
    v_bfe_u32 v163, v1, 3, 1
    v_lshl_or_b32 v162, v163, 5, v162
    v_bfe_u32 v161, v1, 2, 1
    v_lshl_or_b32 v162, v161, 6, v162
    s_add_u32 s74, s5, 49152
    v_lshl_add_u32 v163, v162, 4, s74
    v_xor_b32 v160, 64, v163
    ds_read_b128 v[176:179], v163
    ds_read_b128 v[180:183], v160
    v_lshlrev_b32 v161, 4, v161
    v_mul_u32_u24 v162, 66560, v2
    v_lshl_or_b32 v162, v3, 4, v162
    s_lshl_b32 s76, s67, 5
    s_add_u32 s76, s76, s66
    s_lshl_b32 s76, s76, 8
    s_mul_i32 s74, s65, 532480
    s_add_u32 s76, s76, s74
    s_add_u32 s76, s76, 2097152
    s_add_u32 s74, s76, 266240
    s_waitcnt lgkmcnt(1)
    v_alignbit_b32 v176, v176, v176, v161
    v_alignbit_b32 v177, v177, v177, v161
    v_alignbit_b32 v178, v178, v178, v161
    v_alignbit_b32 v179, v179, v179, v161
    v_and_b32 v176, -2, v176
    buffer_store_dwordx4 v[176:179], v162, s[36:39], s76 offen sc1
    s_waitcnt lgkmcnt(0)
    v_alignbit_b32 v180, v180, v180, v161
    v_alignbit_b32 v181, v181, v181, v161
    v_alignbit_b32 v182, v182, v182, v161
    v_alignbit_b32 v183, v183, v183, v161
    v_and_b32 v180, -2, v180
    buffer_store_dwordx4 v[180:183], v162, s[36:39], s74 offen sc1
    s_lshl1_add_u32 s74, s68, 10
    s_and_b32 s74, s74, 15
    s_mul_i32 s74, s74, 88064
    s_add_u32 m0, s5, 36864
    s_add_u32 s74, s74, s16
    buffer_load_dwordx4 v158, s[28:31], s74 offen offset:0 lds
    s_add_u32 m0, s5, 37760
    s_nop 0
    buffer_load_dwordx4 v158, s[28:31], s74 offen offset:128 lds
    s_add_u32 m0, s5, 38656
    s_nop 0
    buffer_load_dwordx4 v159, s[28:31], s74 offen offset:256 lds
    v_sin_f32 v157, v153
    v_fmamk_f32 v152, v151, 0x41900000, v150
    v_fmamk_f32 v153, v151, 0x41980000, v150
    v_cvt_pk_bf16_f32 v26, v154, v155
    v_cvt_pk_bf16_f32 v58, v156, v157
    v_cos_f32 v154, v152
    v_cos_f32 v155, v153
    v_sin_f32 v156, v152
    v_sin_f32 v157, v153
    v_cvt_pk_bf16_f32 v27, v154, v155
    v_cvt_pk_bf16_f32 v59, v156, v157
    v_and_b32 v152, 1, v1
    v_mul_u32_u24 v152, 0x8000, v152
    v_lshl_or_b32 v152, v152, 16, v152
    s_brev_b32 s12, 1
    s_lshl1_add_u32 s74, s68, 11
    s_and_b32 s74, s74, 15
    s_mul_i32 s74, s74, 88064
    s_add_u32 m0, s5, 49152
    s_add_u32 s74, s74, s16
    buffer_load_dwordx4 v158, s[28:31], s74 offen offset:0 lds
    s_add_u32 m0, s5, 50048
    s_nop 0
    buffer_load_dwordx4 v158, s[28:31], s74 offen offset:128 lds
    s_add_u32 m0, s5, 50944
    s_nop 0
    buffer_load_dwordx4 v159, s[28:31], s74 offen offset:256 lds
    s_lshr_b32 s7, s67, 1
    s_lshr_b32 s74, s66, 2
    s_lshl3_add_u32 s7, s7, s74
    s_lshl_b32 s7, s7, 7
    s_add_u32 s7, s7, 0
    s_cmp_lg_u32 s64, 4
    s_cbranch_scc1 L_y0_35
    s_load_dword s11, s[20:21], s7 glc
L_y0_35:
    v_xor_b32 v20, v152, v16
    v_xor_b32 v21, v152, v17
    v_xor_b32 v22, v152, v18
    v_xor_b32 v23, v152, v19
    v_xor_b32 v32, s12, v16
    v_xor_b32 v33, s12, v17
    v_xor_b32 v34, s12, v18
    v_xor_b32 v35, s12, v19
    v_xor_b32 v36, s12, v20
    v_xor_b32 v37, s12, v21
    v_xor_b32 v38, s12, v22
    v_xor_b32 v39, s12, v23
    v_xor_b32 v28, v152, v24
    v_xor_b32 v29, v152, v25
    v_xor_b32 v30, v152, v26
    v_xor_b32 v31, v152, v27
    v_xor_b32 v40, s12, v24
    v_xor_b32 v41, s12, v25
    v_xor_b32 v42, s12, v26
    v_xor_b32 v43, s12, v27
    v_xor_b32 v44, s12, v28
    v_xor_b32 v45, s12, v29
    v_xor_b32 v46, s12, v30
    v_xor_b32 v47, s12, v31
    v_xor_b32 v52, v152, v48
    v_xor_b32 v53, v152, v49
    v_xor_b32 v54, v152, v50
    v_xor_b32 v55, v152, v51
    v_xor_b32 v64, s12, v48
    v_xor_b32 v65, s12, v49
    v_xor_b32 v66, s12, v50
    v_xor_b32 v67, s12, v51
    v_xor_b32 v68, s12, v52
    v_xor_b32 v69, s12, v53
    v_xor_b32 v70, s12, v54
    v_xor_b32 v71, s12, v55
    v_xor_b32 v60, v152, v56
    v_xor_b32 v61, v152, v57
    v_xor_b32 v62, v152, v58
    v_xor_b32 v63, v152, v59
    v_xor_b32 v72, s12, v56
    v_xor_b32 v73, s12, v57
    v_xor_b32 v74, s12, v58
    v_xor_b32 v75, s12, v59
    v_xor_b32 v76, s12, v60
    v_xor_b32 v77, s12, v61
    v_xor_b32 v78, s12, v62
    v_xor_b32 v79, s12, v63
    s_cmp_lg_u32 s64, 4
    s_cbranch_scc1 L_y0_36
    s_mov_b32 s77, 0
    s_branch L_ss_37_c
L_ss_37:
    s_load_dword s11, s[20:21], s7 glc
L_ss_37_c:
    s_waitcnt lgkmcnt(0)
    s_cmp_ge_u32 s11, 43
    s_cbranch_scc1 L_sd_38
    s_add_u32 s77, s77, 1
    s_cmp_gt_u32 s77, 30000
    s_cbranch_scc1 L_sd_38
    s_sleep 2
    s_branch L_ss_37
L_sd_38:
L_y0_36:
    s_waitcnt vmcnt(6)
    s_barrier
    s_lshl2_add_u32 s74, s67, s65
    s_lshl_b32 s74, s74, 7
    s_add_u32 s74, s74, 4096
    s_atomic_add s10, s[20:21], s74
    s_lshl1_add_u32 s74, s68, 12
    s_and_b32 s74, s74, 15
    s_mul_i32 s74, s74, 88064
    s_add_u32 m0, s5, 65536
    s_add_u32 s74, s74, s16
    buffer_load_dwordx4 v158, s[28:31], s74 offen offset:0 lds
    s_add_u32 m0, s5, 66432
    s_nop 0
    buffer_load_dwordx4 v158, s[28:31], s74 offen offset:128 lds
    s_add_u32 m0, s5, 67328
    s_nop 0
    buffer_load_dwordx4 v159, s[28:31], s74 offen offset:256 lds
    s_lshl1_add_u32 s74, s68, 13
    s_and_b32 s74, s74, 15
    s_mul_i32 s74, s74, 88064
    s_add_u32 m0, s5, 77824
    s_add_u32 s74, s74, s16
    buffer_load_dwordx4 v158, s[28:31], s74 offen offset:0 lds
    s_add_u32 m0, s5, 78720
    s_nop 0
    buffer_load_dwordx4 v158, s[28:31], s74 offen offset:128 lds
    s_add_u32 m0, s5, 79616
    s_nop 0
    buffer_load_dwordx4 v159, s[28:31], s74 offen offset:256 lds
    s_lshl1_add_u32 s74, s68, 14
    s_and_b32 s74, s74, 15
    s_mul_i32 s74, s74, 88064
    s_add_u32 m0, s5, 90112
    s_add_u32 s74, s74, s16
    buffer_load_dwordx4 v158, s[28:31], s74 offen offset:0 lds
    s_add_u32 m0, s5, 91008
    s_nop 0
    buffer_load_dwordx4 v158, s[28:31], s74 offen offset:128 lds
    s_add_u32 m0, s5, 91904
    s_nop 0
    buffer_load_dwordx4 v159, s[28:31], s74 offen offset:256 lds
    s_lshl1_add_u32 s74, s68, 15
    s_and_b32 s74, s74, 15
    s_mul_i32 s74, s74, 88064
    s_add_u32 m0, s5, 102400
    s_add_u32 s74, s74, s16
    buffer_load_dwordx4 v158, s[28:31], s74 offen offset:0 lds
    s_add_u32 m0, s5, 103296
    s_nop 0
    buffer_load_dwordx4 v158, s[28:31], s74 offen offset:128 lds
    s_add_u32 m0, s5, 104192
    s_nop 0
    buffer_load_dwordx4 v159, s[28:31], s74 offen offset:256 lds
    s_waitcnt vmcnt(12)
    s_barrier
    buffer_load_dwordx4 v[240:243], v7, s[56:59], s24 offen offset:0 sc1
    s_nop 0
    buffer_load_dwordx4 v[244:247], v7, s[56:59], s24 offen offset:1024 sc1
    s_nop 0
    buffer_load_dwordx4 v[248:251], v7, s[56:59], s24 offen offset:2048 sc1
    s_nop 0
    buffer_load_dwordx4 v[252:255], v7, s[56:59], s24 offen offset:3072 sc1
    s_nop 0
    s_and_b32 s6, s2, 3
    s_lshl2_add_u32 s6, s67, s6
    s_lshl_b32 s6, s6, 7
    s_add_u32 s6, s6, 4096
    s_cmp_lg_u32 s64, 4
    s_cbranch_scc1 L_y0_39
    s_load_dword s23, s[20:21], s6 glc
L_y0_39:
    s_waitcnt vmcnt(10)
    s_barrier
    buffer_load_dwordx4 v[224:227], v7, s[56:59], s25 offen offset:0 sc1
    s_nop 0
    buffer_load_dwordx4 v[228:231], v7, s[56:59], s25 offen offset:1024 sc1
    s_nop 0
    buffer_load_dwordx4 v[232:235], v7, s[56:59], s25 offen offset:2048 sc1
    s_nop 0
    buffer_load_dwordx4 v[236:239], v7, s[56:59], s25 offen offset:3072 sc1
    s_nop 0
    buffer_load_dwordx4 v[208:211], v7, s[56:59], s26 offen offset:0 sc1
    s_nop 0
    buffer_load_dwordx4 v[212:215], v7, s[56:59], s26 offen offset:1024 sc1
    s_nop 0
    buffer_load_dwordx4 v[216:219], v7, s[56:59], s26 offen offset:2048 sc1
    s_nop 0
    buffer_load_dwordx4 v[220:223], v7, s[56:59], s26 offen offset:3072 sc1
    s_nop 0
    s_cmp_lg_u32 s64, 4
    s_cbranch_scc1 L_y0_40
    s_mov_b32 s77, 0
    s_branch L_ss_41_c
L_ss_41:
    s_load_dword s23, s[20:21], s6 glc
L_ss_41_c:
    s_waitcnt lgkmcnt(0)
    s_cmp_ge_u32 s23, 32
    s_cbranch_scc1 L_sd_42
    s_add_u32 s77, s77, 1
    s_cmp_gt_u32 s77, 30000
    s_cbranch_scc1 L_sd_42
    s_sleep 2
    s_branch L_ss_41
L_sd_42:
L_y0_40:
    s_waitcnt vmcnt(12)
    s_barrier
    s_add_u32 s74, s4, 4096
    buffer_load_dword v112, v147, s[36:39], s4 offen offset:0 sc1
    buffer_load_dword v113, v147, s[36:39], s4 offen offset:256 sc1
    buffer_load_dword v114, v147, s[36:39], s4 offen offset:2048 sc1
    buffer_load_dword v115, v147, s[36:39], s4 offen offset:2304 sc1
    buffer_load_dword v116, v147, s[36:39], s74 offen offset:0 sc1
    buffer_load_dword v117, v147, s[36:39], s74 offen offset:256 sc1
    buffer_load_dword v118, v147, s[36:39], s74 offen offset:2048 sc1
    buffer_load_dword v119, v147, s[36:39], s74 offen offset:2304 sc1
    s_mul_i32 s74, s65, 2560
    s_add_u32 s74, s74, 151552
    v_add_u32 v10, s74, v7
    ds_write_b128 v10, v[128:131] offset:0
    ds_write_b128 v10, v[132:135] offset:1024
    s_mov_b32 exec_hi, 0
    ds_write_b128 v10, v[136:139] offset:2048
    s_mov_b32 exec_hi, -1
    v_mov_b32 v10, 17
    ds_write_b32 v0, v10 offset:32
    ds_read_b32 v9, v8 offset:32
    s_waitcnt lgkmcnt(0)
    v_cmp_gt_u32 vcc, 17, v9
    s_nop 0
    s_cbranch_vccnz L_slow_43
L_back_44:
    v_mul_u32_u24 v12, 320, v2
    v_and_b32 v152, 7, v1
    v_lshl_add_u32 v12, v152, 3, v12
    s_lshl1_add_u32 s13, s66, 2
    s_and_b32 s13, s13, 15
    s_lshl1_add_u32 s13, s65, s13
    s_add_u32 s13, s13, 151552
    v_add_u32 v12, s13, v12
    ds_read_u16_d16_hi v80, v12 offset:0
    ds_read_u16_d16_hi v81, v12 offset:80
    ds_read_u16_d16_hi v82, v12 offset:160
    ds_read_u16_d16_hi v83, v12 offset:240
    ds_read_u16_d16_hi v84, v12 offset:1280
    ds_read_u16_d16_hi v85, v12 offset:1360
    ds_read_u16_d16_hi v86, v12 offset:1440
    ds_read_u16_d16_hi v87, v12 offset:1520
    ds_read_u16_d16_hi v88, v12 offset:2560
    ds_read_u16_d16_hi v89, v12 offset:2640
    ds_read_u16_d16_hi v90, v12 offset:2720
    ds_read_u16_d16_hi v91, v12 offset:2800
    ds_read_u16_d16_hi v92, v12 offset:3840
    ds_read_u16_d16_hi v93, v12 offset:3920
    ds_read_u16_d16_hi v94, v12 offset:4000
    ds_read_u16_d16_hi v95, v12 offset:4080
    ds_read_u16_d16_hi v96, v12 offset:5120
    ds_read_u16_d16_hi v97, v12 offset:5200
    ds_read_u16_d16_hi v98, v12 offset:5280
    ds_read_u16_d16_hi v99, v12 offset:5360
    ds_read_u16_d16_hi v100, v12 offset:6400
    ds_read_u16_d16_hi v101, v12 offset:6480
    ds_read_u16_d16_hi v102, v12 offset:6560
    ds_read_u16_d16_hi v103, v12 offset:6640
    ds_read_u16_d16_hi v104, v12 offset:7680
    ds_read_u16_d16_hi v105, v12 offset:7760
    ds_read_u16_d16_hi v106, v12 offset:7840
    ds_read_u16_d16_hi v107, v12 offset:7920
    ds_read_u16_d16_hi v108, v12 offset:8960
    ds_read_u16_d16_hi v109, v12 offset:9040
    ds_read_u16_d16_hi v110, v12 offset:9120
    ds_read_u16_d16_hi v111, v12 offset:9200
    buffer_load_dwordx4 v[192:195], v7, s[56:59], s27 offen offset:0 sc1
    s_nop 0
    buffer_load_dwordx4 v[196:199], v7, s[56:59], s27 offen offset:1024 sc1
    s_nop 0
    buffer_load_dwordx4 v[200:203], v7, s[56:59], s27 offen offset:2048 sc1
    s_nop 0
    buffer_load_dwordx4 v[204:207], v7, s[56:59], s27 offen offset:3072 sc1
    s_nop 0
    v_bfe_u32 v152, v1, 3, 1
    v_mul_u32_u24 v152, 0x8000, v152
    v_lshl_or_b32 v14, v152, 16, v152
    v_xor_b32 v15, 0x80008000, v14
    v_and_b32 v152, 0x80000000, v15
    s_waitcnt lgkmcnt(0)
    v_xor_b32 v96, v152, v96
    v_xor_b32 v97, v152, v97
    v_xor_b32 v98, v152, v98
    v_xor_b32 v99, v152, v99
    v_xor_b32 v100, v152, v100
    v_xor_b32 v101, v152, v101
    v_xor_b32 v102, v152, v102
    v_xor_b32 v103, v152, v103
    v_xor_b32 v104, v152, v104
    v_xor_b32 v105, v152, v105
    v_xor_b32 v106, v152, v106
    v_xor_b32 v107, v152, v107
    v_xor_b32 v108, v152, v108
    v_xor_b32 v109, v152, v109
    v_xor_b32 v110, v152, v110
    v_xor_b32 v111, v152, v111
    s_lshl2_add_u32 s12, s67, s65
    s_cmp_lg_u32 s12, 31
    s_cbranch_scc1 L_ny_45
    s_mov_b32 exec_lo, 0x80808080
    s_mov_b32 exec_hi, 0x80808080
    v_mul_f32 v80, 0.5, v80
    v_mul_f32 v81, 0.5, v81
    v_mul_f32 v82, 0.5, v82
    v_mul_f32 v83, 0.5, v83
    v_mul_f32 v84, 0.5, v84
    v_mul_f32 v85, 0.5, v85
    v_mul_f32 v86, 0.5, v86
    v_mul_f32 v87, 0.5, v87
    v_mul_f32 v88, 0.5, v88
    v_mul_f32 v89, 0.5, v89
    v_mul_f32 v90, 0.5, v90
    v_mul_f32 v91, 0.5, v91
    v_mul_f32 v92, 0.5, v92
    v_mul_f32 v93, 0.5, v93
    v_mul_f32 v94, 0.5, v94
    v_mul_f32 v95, 0.5, v95
    v_mul_f32 v96, 0.5, v96
    v_mul_f32 v97, 0.5, v97
    v_mul_f32 v98, 0.5, v98
    v_mul_f32 v99, 0.5, v99
    v_mul_f32 v100, 0.5, v100
    v_mul_f32 v101, 0.5, v101
    v_mul_f32 v102, 0.5, v102
    v_mul_f32 v103, 0.5, v103
    v_mul_f32 v104, 0.5, v104
    v_mul_f32 v105, 0.5, v105
    v_mul_f32 v106, 0.5, v106
    v_mul_f32 v107, 0.5, v107
    v_mul_f32 v108, 0.5, v108
    v_mul_f32 v109, 0.5, v109
    v_mul_f32 v110, 0.5, v110
    v_mul_f32 v111, 0.5, v111
    s_mov_b64 exec, -1
L_ny_45:
    s_waitcnt vmcnt(4)
    v_mfma_f32_16x16x32_bf16 v[128:131], v[16:19], v[112:115], 0
    v_xor_b32_dpp v120, v112, v14 row_ror:8 row_mask:0xf bank_mask:0xf
    v_mfma_f32_16x16x32_bf16 v[132:135], v[24:27], v[112:115], 0
    v_xor_b32_dpp v121, v113, v14 row_ror:8 row_mask:0xf bank_mask:0xf
    v_mfma_f32_16x16x32_bf16 v[136:139], v[32:35], v[112:115], 0
    v_xor_b32_dpp v122, v114, v14 row_ror:8 row_mask:0xf bank_mask:0xf
    v_mfma_f32_16x16x32_bf16 v[140:143], v[40:43], v[112:115], 0
    v_xor_b32_dpp v123, v115, v14 row_ror:8 row_mask:0xf bank_mask:0xf
    v_mfma_f32_16x16x32_bf16 v[128:131], v[20:23], v[116:119], v[128:131]
    v_xor_b32_dpp v124, v116, v14 row_ror:8 row_mask:0xf bank_mask:0xf
    v_mfma_f32_16x16x32_bf16 v[132:135], v[28:31], v[116:119], v[132:135]
    v_xor_b32_dpp v125, v117, v14 row_ror:8 row_mask:0xf bank_mask:0xf
    v_mfma_f32_16x16x32_bf16 v[136:139], v[36:39], v[116:119], v[136:139]
    v_xor_b32_dpp v126, v118, v14 row_ror:8 row_mask:0xf bank_mask:0xf
    v_mfma_f32_16x16x32_bf16 v[140:143], v[44:47], v[116:119], v[140:143]
    v_xor_b32_dpp v127, v119, v14 row_ror:8 row_mask:0xf bank_mask:0xf
    v_mfma_f32_16x16x32_bf16 v[128:131], v[48:51], v[120:123], v[128:131]
    s_nop 0
    v_mfma_f32_16x16x32_bf16 v[128:131], v[52:55], v[124:127], v[128:131]
    v_mfma_f32_16x16x32_bf16 v[132:135], v[56:59], v[120:123], v[132:135]
    v_mfma_f32_16x16x32_bf16 v[132:135], v[60:63], v[124:127], v[132:135]
    v_mfma_f32_16x16x32_bf16 v[136:139], v[64:67], v[120:123], v[136:139]
    v_mfma_f32_16x16x32_bf16 v[136:139], v[68:71], v[124:127], v[136:139]
    v_mfma_f32_16x16x32_bf16 v[140:143], v[72:75], v[120:123], v[140:143]
    v_mfma_f32_16x16x32_bf16 v[140:143], v[76:79], v[124:127], v[140:143]
    s_nop 1
    v_mul_f32 v80, v128, v80
    v_mul_f32 v81, v129, v81
    v_mul_f32 v82, v130, v82
    v_mul_f32 v83, v131, v83
    v_fmac_f32_dpp v80, v128, v96 row_ror:8 row_mask:0xf bank_mask:0xf
    v_fmac_f32_dpp v81, v129, v97 row_ror:8 row_mask:0xf bank_mask:0xf
    v_fmac_f32_dpp v82, v130, v98 row_ror:8 row_mask:0xf bank_mask:0xf
    v_fmac_f32_dpp v83, v131, v99 row_ror:8 row_mask:0xf bank_mask:0xf
    v_cvt_pk_bf16_f32 v112, v80, v81
    v_cvt_pk_bf16_f32 v113, v82, v83
    v_mul_f32 v84, v132, v84
    v_mul_f32 v85, v133, v85
    v_mul_f32 v86, v134, v86
    v_mul_f32 v87, v135, v87
    v_fmac_f32_dpp v84, v132, v100 row_ror:8 row_mask:0xf bank_mask:0xf
    v_fmac_f32_dpp v85, v133, v101 row_ror:8 row_mask:0xf bank_mask:0xf
    v_fmac_f32_dpp v86, v134, v102 row_ror:8 row_mask:0xf bank_mask:0xf
    v_fmac_f32_dpp v87, v135, v103 row_ror:8 row_mask:0xf bank_mask:0xf
    v_cvt_pk_bf16_f32 v114, v84, v85
    v_cvt_pk_bf16_f32 v115, v86, v87
    v_mul_f32 v88, v136, v88
    v_mul_f32 v89, v137, v89
    v_mul_f32 v90, v138, v90
    v_mul_f32 v91, v139, v91
    v_fmac_f32_dpp v88, v136, v104 row_ror:8 row_mask:0xf bank_mask:0xf
    v_fmac_f32_dpp v89, v137, v105 row_ror:8 row_mask:0xf bank_mask:0xf
    v_fmac_f32_dpp v90, v138, v106 row_ror:8 row_mask:0xf bank_mask:0xf
    v_fmac_f32_dpp v91, v139, v107 row_ror:8 row_mask:0xf bank_mask:0xf
    v_cvt_pk_bf16_f32 v116, v88, v89
    v_cvt_pk_bf16_f32 v117, v90, v91
    v_mul_f32 v92, v140, v92
    v_mul_f32 v93, v141, v93
    v_mul_f32 v94, v142, v94
    v_mul_f32 v95, v143, v95
    v_fmac_f32_dpp v92, v140, v108 row_ror:8 row_mask:0xf bank_mask:0xf
    v_fmac_f32_dpp v93, v141, v109 row_ror:8 row_mask:0xf bank_mask:0xf
    v_fmac_f32_dpp v94, v142, v110 row_ror:8 row_mask:0xf bank_mask:0xf
    v_fmac_f32_dpp v95, v143, v111 row_ror:8 row_mask:0xf bank_mask:0xf
    v_cvt_pk_bf16_f32 v118, v92, v93
    v_cvt_pk_bf16_f32 v119, v94, v95
    v_mfma_f32_16x16x32_bf16 v[128:131], v[112:115], v[16:19], 0
    v_xor_b32_dpp v120, v112, v15 row_ror:8 row_mask:0xf bank_mask:0xf
    v_mfma_f32_16x16x32_bf16 v[132:135], v[112:115], v[24:27], 0
    v_xor_b32_dpp v121, v113, v15 row_ror:8 row_mask:0xf bank_mask:0xf
    v_mfma_f32_16x16x32_bf16 v[136:139], v[112:115], v[32:35], 0
    v_xor_b32_dpp v122, v114, v15 row_ror:8 row_mask:0xf bank_mask:0xf
    v_mfma_f32_16x16x32_bf16 v[140:143], v[112:115], v[40:43], 0
    v_xor_b32_dpp v123, v115, v15 row_ror:8 row_mask:0xf bank_mask:0xf
    v_mfma_f32_16x16x32_bf16 v[128:131], v[116:119], v[20:23], v[128:131]
    v_xor_b32_dpp v124, v116, v15 row_ror:8 row_mask:0xf bank_mask:0xf
    v_mfma_f32_16x16x32_bf16 v[132:135], v[116:119], v[28:31], v[132:135]
    v_xor_b32_dpp v125, v117, v15 row_ror:8 row_mask:0xf bank_mask:0xf
    v_mfma_f32_16x16x32_bf16 v[136:139], v[116:119], v[36:39], v[136:139]
    v_xor_b32_dpp v126, v118, v15 row_ror:8 row_mask:0xf bank_mask:0xf
    v_mfma_f32_16x16x32_bf16 v[140:143], v[116:119], v[44:47], v[140:143]
    v_xor_b32_dpp v127, v119, v15 row_ror:8 row_mask:0xf bank_mask:0xf
    v_mfma_f32_16x16x32_bf16 v[128:131], v[120:123], v[48:51], v[128:131]
    s_nop 0
    v_mfma_f32_16x16x32_bf16 v[128:131], v[124:127], v[52:55], v[128:131]
    v_mfma_f32_16x16x32_bf16 v[132:135], v[120:123], v[56:59], v[132:135]
    v_mfma_f32_16x16x32_bf16 v[132:135], v[124:127], v[60:63], v[132:135]
    v_mfma_f32_16x16x32_bf16 v[136:139], v[120:123], v[64:67], v[136:139]
    v_mfma_f32_16x16x32_bf16 v[136:139], v[124:127], v[68:71], v[136:139]
    v_mfma_f32_16x16x32_bf16 v[140:143], v[120:123], v[72:75], v[140:143]
    v_mfma_f32_16x16x32_bf16 v[140:143], v[124:127], v[76:79], v[140:143]
    s_nop 1
    v_cvt_pk_bf16_f32 v80, v128, v129
    v_cvt_pk_bf16_f32 v81, v130, v131
    ds_write_b64 v144, v[80:81] offset:0
    v_cvt_pk_bf16_f32 v82, v132, v133
    v_cvt_pk_bf16_f32 v83, v134, v135
    ds_write_b64 v144, v[82:83] offset:512
    v_cvt_pk_bf16_f32 v84, v136, v137
    v_cvt_pk_bf16_f32 v85, v138, v139
    ds_write_b64 v144, v[84:85] offset:1024
    v_cvt_pk_bf16_f32 v86, v140, v141
    v_cvt_pk_bf16_f32 v87, v142, v143
    ds_write_b64 v144, v[86:87] offset:1536
    ds_read_b128 v[16:19], v145 offset:0
    ds_read_b128 v[20:23], v145 offset:1024
    s_add_u32 s76, s4, 4096
    s_waitcnt lgkmcnt(1)
    v_or_b32 v16, 1, v16
    buffer_store_dwordx4 v[16:19], v11, s[36:39], s4 offen sc1
    s_waitcnt lgkmcnt(0)
    v_or_b32 v20, 1, v20
    buffer_store_dwordx4 v[20:23], v11, s[36:39], s76 offen sc1
    v_mov_b32 v10, 18
    ds_write_b32 v0, v10 offset:32
    v_and_b32 v12, 7, v1
    v_xor_b32 v12, v12, v2
    v_lshlrev_b32 v12, 4, v12
    v_lshl_or_b32 v12, v3, 8, v12
    s_lshl_b32 s74, s65, 12
    s_add_u32 s74, s74, 24576
    v_add_u32 v12, s74, v12
    v_xor_b32 v5, 64, v12
    s_sub_u32 s74, s65, s71
    s_and_b32 s74, s74, 3
    s_lshl_b32 s74, s74, 12
    v_add_u32 v4, s74, v7
    s_setprio 1
    buffer_load_dwordx4 v[176:179], v7, s[56:59], s32 offen offset:0 sc1
    s_nop 0
    buffer_load_dwordx4 v[180:183], v7, s[56:59], s32 offen offset:1024 sc1
    s_nop 0
    buffer_load_dwordx4 v[184:187], v7, s[56:59], s32 offen offset:2048 sc1
    s_nop 0
    buffer_load_dwordx4 v[188:191], v7, s[56:59], s32 offen offset:3072 sc1
    s_nop 0
    buffer_load_dwordx4 v[160:163], v7, s[56:59], s33 offen offset:0 sc1
    s_nop 0
    buffer_load_dwordx4 v[164:167], v7, s[56:59], s33 offen offset:1024 sc1
    s_nop 0
    buffer_load_dwordx4 v[168:171], v7, s[56:59], s33 offen offset:2048 sc1
    s_nop 0
    buffer_load_dwordx4 v[172:175], v7, s[56:59], s33 offen offset:3072 sc1
    s_nop 0
    buffer_load_dwordx4 v[144:147], v7, s[56:59], s34 offen offset:0 sc1
    s_nop 0
    buffer_load_dwordx4 v[148:151], v7, s[56:59], s34 offen offset:1024 sc1
    s_nop 0
    buffer_load_dwordx4 v[152:155], v7, s[56:59], s34 offen offset:2048 sc1
    s_nop 0
    buffer_load_dwordx4 v[156:159], v7, s[56:59], s34 offen offset:3072 sc1
    s_nop 0
    buffer_load_dwordx4 v[128:131], v7, s[56:59], s35 offen offset:0 sc1
    s_nop 0
    buffer_load_dwordx4 v[132:135], v7, s[56:59], s35 offen offset:1024 sc1
    s_nop 0
    buffer_load_dwordx4 v[136:139], v7, s[56:59], s35 offen offset:2048 sc1
    s_nop 0
    buffer_load_dwordx4 v[140:143], v7, s[56:59], s35 offen offset:3072 sc1
    s_nop 0
    buffer_load_dwordx4 v[112:115], v7, s[56:59], s40 offen offset:0 sc1
    s_nop 0
    buffer_load_dwordx4 v[116:119], v7, s[56:59], s40 offen offset:1024 sc1
    s_nop 0
    buffer_load_dwordx4 v[120:123], v7, s[56:59], s40 offen offset:2048 sc1
    s_nop 0
    buffer_load_dwordx4 v[124:127], v7, s[56:59], s40 offen offset:3072 sc1
    s_nop 0
    buffer_load_dwordx4 v[96:99], v7, s[56:59], s41 offen offset:0 sc1
    s_nop 0
    buffer_load_dwordx4 v[100:103], v7, s[56:59], s41 offen offset:1024 sc1
    s_nop 0
    buffer_load_dwordx4 v[104:107], v7, s[56:59], s41 offen offset:2048 sc1
    s_nop 0
    buffer_load_dwordx4 v[108:111], v7, s[56:59], s41 offen offset:3072 sc1
    s_nop 0
    buffer_load_dwordx4 v[80:83], v7, s[56:59], s42 offen offset:0 sc1
    s_nop 0
    buffer_load_dwordx4 v[84:87], v7, s[56:59], s42 offen offset:1024 sc1
    s_nop 0
    buffer_load_dwordx4 v[88:91], v7, s[56:59], s42 offen offset:2048 sc1
    s_nop 0
    buffer_load_dwordx4 v[92:95], v7, s[56:59], s42 offen offset:3072 sc1
    s_nop 0
    s_mov_b32 s77, 0
L_ls_46:
    ds_read_b32 v9, v13 offset:8
    s_waitcnt lgkmcnt(0)
    v_cmp_ne_u32 vcc, 1, v9
    s_add_u32 s77, s77, 1
    s_nop 0
    s_cbranch_vccz L_ld_47
    s_cmp_gt_u32 s77, 0x80000
    s_cbranch_scc1 L_ld_47
    s_sleep 1
    s_branch L_ls_46
L_ld_47:
    s_setprio 1
    v_mov_b32 v2, v12
    ds_read_b128 v[44:47], v4 offset:8192
    buffer_load_dwordx4 v[40:43], v7, s[52:55], s25 offen offset:0 sc1
    s_nop 0
    buffer_load_dwordx4 v[36:39], v7, s[52:55], s26 offen offset:0 sc1
    s_nop 0
    buffer_load_dwordx4 v[32:35], v7, s[52:55], s27 offen offset:0 sc1
    s_nop 0
    buffer_load_dwordx4 v[48:51], v7, s[52:55], s32 offen offset:0 sc1
    s_nop 0
    buffer_load_dwordx4 v[52:55], v7, s[52:55], s33 offen offset:0 sc1
    s_nop 0
    buffer_load_dwordx4 v[56:59], v7, s[52:55], s34 offen offset:0 sc1
    s_nop 0
    buffer_load_dwordx4 v[60:63], v7, s[52:55], s35 offen offset:0 sc1
    s_nop 0
    buffer_load_dwordx4 v[64:67], v7, s[52:55], s40 offen offset:0 sc1
    s_nop 0
    s_waitcnt lgkmcnt(0)
    v_mfma_f32_16x16x32_bf16 v[16:19], v[240:243], v[44:47], 0
    v_mfma_f32_16x16x32_bf16 v[20:23], v[244:247], v[44:47], 0
    buffer_load_dwordx4 v[68:71], v7, s[52:55], s41 offen offset:0 sc1
    v_mfma_f32_16x16x32_bf16 v[24:27], v[248:251], v[44:47], 0
    v_mfma_f32_16x16x32_bf16 v[28:31], v[252:255], v[44:47], 0
    buffer_load_dwordx4 v[72:75], v7, s[52:55], s42 offen offset:0 sc1
    s_waitcnt vmcnt(9)
    v_mfma_f32_16x16x32_bf16 v[16:19], v[224:227], v[40:43], v[16:19]
    v_mfma_f32_16x16x32_bf16 v[20:23], v[228:231], v[40:43], v[20:23]
    buffer_load_dwordx4 v[76:79], v7, s[52:55], s25 offen offset:1024 sc1
    v_mfma_f32_16x16x32_bf16 v[24:27], v[232:235], v[40:43], v[24:27]
    v_mfma_f32_16x16x32_bf16 v[28:31], v[236:239], v[40:43], v[28:31]
    buffer_load_dwordx4 v[8:11], v7, s[52:55], s26 offen offset:1024 sc1
    s_waitcnt vmcnt(10)
    v_mfma_f32_16x16x32_bf16 v[16:19], v[208:211], v[36:39], v[16:19]
    v_mfma_f32_16x16x32_bf16 v[20:23], v[212:215], v[36:39], v[20:23]
    buffer_load_dwordx4 v[12:15], v7, s[52:55], s27 offen offset:1024 sc1
    v_mfma_f32_16x16x32_bf16 v[24:27], v[216:219], v[36:39], v[24:27]
    v_mfma_f32_16x16x32_bf16 v[28:31], v[220:223], v[36:39], v[28:31]
    s_waitcnt vmcnt(10)
    v_mfma_f32_16x16x32_bf16 v[16:19], v[192:195], v[32:35], v[16:19]
    v_mfma_f32_16x16x32_bf16 v[20:23], v[196:199], v[32:35], v[20:23]
    v_mfma_f32_16x16x32_bf16 v[24:27], v[200:203], v[32:35], v[24:27]
    v_mfma_f32_16x16x32_bf16 v[28:31], v[204:207], v[32:35], v[28:31]
    s_waitcnt vmcnt(9)
    v_mfma_f32_16x16x32_bf16 v[16:19], v[176:179], v[48:51], v[16:19]
    v_mfma_f32_16x16x32_bf16 v[20:23], v[180:183], v[48:51], v[20:23]
    v_mfma_f32_16x16x32_bf16 v[24:27], v[184:187], v[48:51], v[24:27]
    v_mfma_f32_16x16x32_bf16 v[28:31], v[188:191], v[48:51], v[28:31]
    buffer_load_dwordx4 v[48:51], v7, s[52:55], s32 offen offset:1024 sc1
    s_waitcnt vmcnt(9)
    v_mfma_f32_16x16x32_bf16 v[16:19], v[160:163], v[52:55], v[16:19]
    v_mfma_f32_16x16x32_bf16 v[20:23], v[164:167], v[52:55], v[20:23]
    v_mfma_f32_16x16x32_bf16 v[24:27], v[168:171], v[52:55], v[24:27]
    v_mfma_f32_16x16x32_bf16 v[28:31], v[172:175], v[52:55], v[28:31]
    buffer_load_dwordx4 v[52:55], v7, s[52:55], s33 offen offset:1024 sc1
    s_waitcnt vmcnt(9)
    v_mfma_f32_16x16x32_bf16 v[16:19], v[144:147], v[56:59], v[16:19]
    v_mfma_f32_16x16x32_bf16 v[20:23], v[148:151], v[56:59], v[20:23]
    v_mfma_f32_16x16x32_bf16 v[24:27], v[152:155], v[56:59], v[24:27]
    v_mfma_f32_16x16x32_bf16 v[28:31], v[156:159], v[56:59], v[28:31]
    buffer_load_dwordx4 v[56:59], v7, s[52:55], s34 offen offset:1024 sc1
    s_waitcnt vmcnt(9)
    v_mfma_f32_16x16x32_bf16 v[16:19], v[128:131], v[60:63], v[16:19]
    v_mfma_f32_16x16x32_bf16 v[20:23], v[132:135], v[60:63], v[20:23]
    v_mfma_f32_16x16x32_bf16 v[24:27], v[136:139], v[60:63], v[24:27]
    v_mfma_f32_16x16x32_bf16 v[28:31], v[140:143], v[60:63], v[28:31]
    buffer_load_dwordx4 v[60:63], v7, s[52:55], s35 offen offset:1024 sc1
    s_waitcnt vmcnt(9)
    v_mfma_f32_16x16x32_bf16 v[16:19], v[112:115], v[64:67], v[16:19]
    v_mfma_f32_16x16x32_bf16 v[20:23], v[116:119], v[64:67], v[20:23]
    v_mfma_f32_16x16x32_bf16 v[24:27], v[120:123], v[64:67], v[24:27]
    v_mfma_f32_16x16x32_bf16 v[28:31], v[124:127], v[64:67], v[28:31]
    ds_read_b128 v[64:67], v4 offset:9216
    s_waitcnt vmcnt(8)
    v_mfma_f32_16x16x32_bf16 v[16:19], v[96:99], v[68:71], v[16:19]
    v_mfma_f32_16x16x32_bf16 v[20:23], v[100:103], v[68:71], v[20:23]
    v_mfma_f32_16x16x32_bf16 v[24:27], v[104:107], v[68:71], v[24:27]
    v_mfma_f32_16x16x32_bf16 v[28:31], v[108:111], v[68:71], v[28:31]
    buffer_load_dwordx4 v[68:71], v7, s[52:55], s40 offen offset:1024 sc1
    s_waitcnt vmcnt(8)
    v_mfma_f32_16x16x32_bf16 v[16:19], v[80:83], v[72:75], v[16:19]
    v_mfma_f32_16x16x32_bf16 v[20:23], v[84:87], v[72:75], v[20:23]
    v_mfma_f32_16x16x32_bf16 v[24:27], v[88:91], v[72:75], v[24:27]
    v_mfma_f32_16x16x32_bf16 v[28:31], v[92:95], v[72:75], v[28:31]
    buffer_load_dwordx4 v[72:75], v7, s[52:55], s41 offen offset:1024 sc1
    s_waitcnt lgkmcnt(0)
    v_mfma_f32_16x16x32_bf16 v[32:35], v[240:243], v[64:67], 0
    v_mfma_f32_16x16x32_bf16 v[36:39], v[244:247], v[64:67], 0
    v_mfma_f32_16x16x32_bf16 v[40:43], v[248:251], v[64:67], 0
    v_mfma_f32_16x16x32_bf16 v[44:47], v[252:255], v[64:67], 0
    buffer_load_dwordx4 v[64:67], v7, s[52:55], s42 offen offset:1024 sc1
    s_waitcnt vmcnt(9)
    v_mfma_f32_16x16x32_bf16 v[32:35], v[224:227], v[76:79], v[32:35]
    v_mfma_f32_16x16x32_bf16 v[36:39], v[228:231], v[76:79], v[36:39]
    v_mfma_f32_16x16x32_bf16 v[40:43], v[232:235], v[76:79], v[40:43]
    ds_write_b128 v2, v[16:19] offset:0
    v_mfma_f32_16x16x32_bf16 v[44:47], v[236:239], v[76:79], v[44:47]
    buffer_load_dwordx4 v[76:79], v7, s[52:55], s25 offen offset:2048 sc1
    s_waitcnt vmcnt(9)
    v_mfma_f32_16x16x32_bf16 v[32:35], v[208:211], v[8:11], v[32:35]
    v_mfma_f32_16x16x32_bf16 v[36:39], v[212:215], v[8:11], v[36:39]
    v_mfma_f32_16x16x32_bf16 v[40:43], v[216:219], v[8:11], v[40:43]
    ds_write_b128 v5, v[20:23] offset:0
    v_mfma_f32_16x16x32_bf16 v[44:47], v[220:223], v[8:11], v[44:47]
    buffer_load_dwordx4 v[8:11], v7, s[52:55], s26 offen offset:2048 sc1
    s_waitcnt vmcnt(9)
    v_mfma_f32_16x16x32_bf16 v[32:35], v[192:195], v[12:15], v[32:35]
    v_mfma_f32_16x16x32_bf16 v[36:39], v[196:199], v[12:15], v[36:39]
    v_mfma_f32_16x16x32_bf16 v[40:43], v[200:203], v[12:15], v[40:43]
    ds_write_b128 v2, v[24:27] offset:128
    v_mfma_f32_16x16x32_bf16 v[44:47], v[204:207], v[12:15], v[44:47]
    buffer_load_dwordx4 v[12:15], v7, s[52:55], s27 offen offset:2048 sc1
    s_waitcnt vmcnt(9)
    v_mfma_f32_16x16x32_bf16 v[32:35], v[176:179], v[48:51], v[32:35]
    v_mfma_f32_16x16x32_bf16 v[36:39], v[180:183], v[48:51], v[36:39]
    v_mfma_f32_16x16x32_bf16 v[40:43], v[184:187], v[48:51], v[40:43]
    ds_write_b128 v5, v[28:31] offset:128
    v_mov_b32 v3, 19
    ds_write_b32 v0, v3 offset:32
    v_mfma_f32_16x16x32_bf16 v[44:47], v[188:191], v[48:51], v[44:47]
    buffer_load_dwordx4 v[48:51], v7, s[52:55], s32 offen offset:2048 sc1
    s_waitcnt vmcnt(9)
    v_mfma_f32_16x16x32_bf16 v[32:35], v[160:163], v[52:55], v[32:35]
    v_mfma_f32_16x16x32_bf16 v[36:39], v[164:167], v[52:55], v[36:39]
    v_mfma_f32_16x16x32_bf16 v[40:43], v[168:171], v[52:55], v[40:43]
    v_mfma_f32_16x16x32_bf16 v[44:47], v[172:175], v[52:55], v[44:47]
    buffer_load_dwordx4 v[52:55], v7, s[52:55], s33 offen offset:2048 sc1
    s_waitcnt vmcnt(9)
    v_mfma_f32_16x16x32_bf16 v[32:35], v[144:147], v[56:59], v[32:35]
    v_mfma_f32_16x16x32_bf16 v[36:39], v[148:151], v[56:59], v[36:39]
    v_mfma_f32_16x16x32_bf16 v[40:43], v[152:155], v[56:59], v[40:43]
    v_mfma_f32_16x16x32_bf16 v[44:47], v[156:159], v[56:59], v[44:47]
    buffer_load_dwordx4 v[56:59], v7, s[52:55], s34 offen offset:2048 sc1
    s_waitcnt vmcnt(9)
    v_mfma_f32_16x16x32_bf16 v[32:35], v[128:131], v[60:63], v[32:35]
    v_mfma_f32_16x16x32_bf16 v[36:39], v[132:135], v[60:63], v[36:39]
    v_mfma_f32_16x16x32_bf16 v[40:43], v[136:139], v[60:63], v[40:43]
    v_mfma_f32_16x16x32_bf16 v[44:47], v[140:143], v[60:63], v[44:47]
    buffer_load_dwordx4 v[60:63], v7, s[52:55], s35 offen offset:2048 sc1
    s_waitcnt vmcnt(9)
    v_mfma_f32_16x16x32_bf16 v[32:35], v[112:115], v[68:71], v[32:35]
    v_mfma_f32_16x16x32_bf16 v[36:39], v[116:119], v[68:71], v[36:39]
    v_mfma_f32_16x16x32_bf16 v[40:43], v[120:123], v[68:71], v[40:43]
    v_mfma_f32_16x16x32_bf16 v[44:47], v[124:127], v[68:71], v[44:47]
    ds_read_b128 v[68:71], v4 offset:10240
    s_waitcnt vmcnt(8)
    v_mfma_f32_16x16x32_bf16 v[32:35], v[96:99], v[72:75], v[32:35]
    v_mfma_f32_16x16x32_bf16 v[36:39], v[100:103], v[72:75], v[36:39]
    v_mfma_f32_16x16x32_bf16 v[40:43], v[104:107], v[72:75], v[40:43]
    v_mfma_f32_16x16x32_bf16 v[44:47], v[108:111], v[72:75], v[44:47]
    buffer_load_dwordx4 v[72:75], v7, s[52:55], s40 offen offset:2048 sc1
    s_waitcnt vmcnt(8)
    v_mfma_f32_16x16x32_bf16 v[32:35], v[80:83], v[64:67], v[32:35]
    v_mfma_f32_16x16x32_bf16 v[36:39], v[84:87], v[64:67], v[36:39]
    v_mfma_f32_16x16x32_bf16 v[40:43], v[88:91], v[64:67], v[40:43]
    v_mfma_f32_16x16x32_bf16 v[44:47], v[92:95], v[64:67], v[44:47]
    buffer_load_dwordx4 v[64:67], v7, s[52:55], s41 offen offset:2048 sc1
    s_waitcnt lgkmcnt(0)
    v_mfma_f32_16x16x32_bf16 v[16:19], v[240:243], v[68:71], 0
    v_mfma_f32_16x16x32_bf16 v[20:23], v[244:247], v[68:71], 0
    v_mfma_f32_16x16x32_bf16 v[24:27], v[248:251], v[68:71], 0
    v_mfma_f32_16x16x32_bf16 v[28:31], v[252:255], v[68:71], 0
    buffer_load_dwordx4 v[68:71], v7, s[52:55], s42 offen offset:2048 sc1
    s_waitcnt vmcnt(9)
    v_mfma_f32_16x16x32_bf16 v[16:19], v[224:227], v[76:79], v[16:19]
    v_mfma_f32_16x16x32_bf16 v[20:23], v[228:231], v[76:79], v[20:23]
    v_mfma_f32_16x16x32_bf16 v[24:27], v[232:235], v[76:79], v[24:27]
    ds_write_b128 v2, v[32:35] offset:16384
    v_mfma_f32_16x16x32_bf16 v[28:31], v[236:239], v[76:79], v[28:31]
    buffer_load_dwordx4 v[76:79], v7, s[52:55], s25 offen offset:3072 sc1
    s_waitcnt vmcnt(9)
    v_mfma_f32_16x16x32_bf16 v[16:19], v[208:211], v[8:11], v[16:19]
    v_mfma_f32_16x16x32_bf16 v[20:23], v[212:215], v[8:11], v[20:23]
    v_mfma_f32_16x16x32_bf16 v[24:27], v[216:219], v[8:11], v[24:27]
    ds_write_b128 v5, v[36:39] offset:16384
    v_mfma_f32_16x16x32_bf16 v[28:31], v[220:223], v[8:11], v[28:31]
    buffer_load_dwordx4 v[8:11], v7, s[52:55], s26 offen offset:3072 sc1
    s_waitcnt vmcnt(9)
    v_mfma_f32_16x16x32_bf16 v[16:19], v[192:195], v[12:15], v[16:19]
    v_mfma_f32_16x16x32_bf16 v[20:23], v[196:199], v[12:15], v[20:23]
    v_mfma_f32_16x16x32_bf16 v[24:27], v[200:203], v[12:15], v[24:27]
    ds_write_b128 v2, v[40:43] offset:16512
    v_mfma_f32_16x16x32_bf16 v[28:31], v[204:207], v[12:15], v[28:31]
    buffer_load_dwordx4 v[12:15], v7, s[52:55], s27 offen offset:3072 sc1
    s_waitcnt vmcnt(9)
    v_mfma_f32_16x16x32_bf16 v[16:19], v[176:179], v[48:51], v[16:19]
    v_mfma_f32_16x16x32_bf16 v[20:23], v[180:183], v[48:51], v[20:23]
    v_mfma_f32_16x16x32_bf16 v[24:27], v[184:187], v[48:51], v[24:27]
    ds_write_b128 v5, v[44:47] offset:16512
    v_mov_b32 v3, 20
    ds_write_b32 v0, v3 offset:32
    v_mfma_f32_16x16x32_bf16 v[28:31], v[188:191], v[48:51], v[28:31]
    buffer_load_dwordx4 v[48:51], v7, s[52:55], s32 offen offset:3072 sc1
    s_waitcnt vmcnt(9)
    v_mfma_f32_16x16x32_bf16 v[16:19], v[160:163], v[52:55], v[16:19]
    v_mfma_f32_16x16x32_bf16 v[20:23], v[164:167], v[52:55], v[20:23]
    v_mfma_f32_16x16x32_bf16 v[24:27], v[168:171], v[52:55], v[24:27]
    v_mfma_f32_16x16x32_bf16 v[28:31], v[172:175], v[52:55], v[28:31]
    buffer_load_dwordx4 v[52:55], v7, s[52:55], s33 offen offset:3072 sc1
    s_waitcnt vmcnt(9)
    v_mfma_f32_16x16x32_bf16 v[16:19], v[144:147], v[56:59], v[16:19]
    v_mfma_f32_16x16x32_bf16 v[20:23], v[148:151], v[56:59], v[20:23]
    v_mfma_f32_16x16x32_bf16 v[24:27], v[152:155], v[56:59], v[24:27]
    v_mfma_f32_16x16x32_bf16 v[28:31], v[156:159], v[56:59], v[28:31]
    buffer_load_dwordx4 v[56:59], v7, s[52:55], s34 offen offset:3072 sc1
    s_waitcnt vmcnt(9)
    v_mfma_f32_16x16x32_bf16 v[16:19], v[128:131], v[60:63], v[16:19]
    v_mfma_f32_16x16x32_bf16 v[20:23], v[132:135], v[60:63], v[20:23]
    v_mfma_f32_16x16x32_bf16 v[24:27], v[136:139], v[60:63], v[24:27]
    v_mfma_f32_16x16x32_bf16 v[28:31], v[140:143], v[60:63], v[28:31]
    buffer_load_dwordx4 v[60:63], v7, s[52:55], s35 offen offset:3072 sc1
    s_waitcnt vmcnt(9)
    v_mfma_f32_16x16x32_bf16 v[16:19], v[112:115], v[72:75], v[16:19]
    v_mfma_f32_16x16x32_bf16 v[20:23], v[116:119], v[72:75], v[20:23]
    v_mfma_f32_16x16x32_bf16 v[24:27], v[120:123], v[72:75], v[24:27]
    v_mfma_f32_16x16x32_bf16 v[28:31], v[124:127], v[72:75], v[28:31]
    ds_read_b128 v[72:75], v4 offset:11264
    s_waitcnt vmcnt(8)
    v_mfma_f32_16x16x32_bf16 v[16:19], v[96:99], v[64:67], v[16:19]
    v_mfma_f32_16x16x32_bf16 v[20:23], v[100:103], v[64:67], v[20:23]
    v_mfma_f32_16x16x32_bf16 v[24:27], v[104:107], v[64:67], v[24:27]
    v_mfma_f32_16x16x32_bf16 v[28:31], v[108:111], v[64:67], v[28:31]
    buffer_load_dwordx4 v[64:67], v7, s[52:55], s40 offen offset:3072 sc1
    s_waitcnt vmcnt(8)
    v_mfma_f32_16x16x32_bf16 v[16:19], v[80:83], v[68:71], v[16:19]
    v_mfma_f32_16x16x32_bf16 v[20:23], v[84:87], v[68:71], v[20:23]
    v_mfma_f32_16x16x32_bf16 v[24:27], v[88:91], v[68:71], v[24:27]
    v_mfma_f32_16x16x32_bf16 v[28:31], v[92:95], v[68:71], v[28:31]
    buffer_load_dwordx4 v[68:71], v7, s[52:55], s41 offen offset:3072 sc1
    s_waitcnt lgkmcnt(0)
    v_mfma_f32_16x16x32_bf16 v[32:35], v[240:243], v[72:75], 0
    v_mfma_f32_16x16x32_bf16 v[36:39], v[244:247], v[72:75], 0
    v_mfma_f32_16x16x32_bf16 v[40:43], v[248:251], v[72:75], 0
    v_mfma_f32_16x16x32_bf16 v[44:47], v[252:255], v[72:75], 0
    buffer_load_dwordx4 v[72:75], v7, s[52:55], s42 offen offset:3072 sc1
    s_waitcnt vmcnt(9)
    v_mfma_f32_16x16x32_bf16 v[32:35], v[224:227], v[76:79], v[32:35]
    v_mfma_f32_16x16x32_bf16 v[36:39], v[228:231], v[76:79], v[36:39]
    v_mfma_f32_16x16x32_bf16 v[40:43], v[232:235], v[76:79], v[40:43]
    ds_write_b128 v2, v[16:19] offset:32768
    v_mfma_f32_16x16x32_bf16 v[44:47], v[236:239], v[76:79], v[44:47]
    s_waitcnt vmcnt(8)
    v_mfma_f32_16x16x32_bf16 v[32:35], v[208:211], v[8:11], v[32:35]
    v_mfma_f32_16x16x32_bf16 v[36:39], v[212:215], v[8:11], v[36:39]
    v_mfma_f32_16x16x32_bf16 v[40:43], v[216:219], v[8:11], v[40:43]
    ds_write_b128 v5, v[20:23] offset:32768
    v_mfma_f32_16x16x32_bf16 v[44:47], v[220:223], v[8:11], v[44:47]
    s_waitcnt vmcnt(7)
    v_mfma_f32_16x16x32_bf16 v[32:35], v[192:195], v[12:15], v[32:35]
    v_mfma_f32_16x16x32_bf16 v[36:39], v[196:199], v[12:15], v[36:39]
    v_mfma_f32_16x16x32_bf16 v[40:43], v[200:203], v[12:15], v[40:43]
    ds_write_b128 v2, v[24:27] offset:32896
    v_mfma_f32_16x16x32_bf16 v[44:47], v[204:207], v[12:15], v[44:47]
    s_waitcnt vmcnt(6)
    v_mfma_f32_16x16x32_bf16 v[32:35], v[176:179], v[48:51], v[32:35]
    v_mfma_f32_16x16x32_bf16 v[36:39], v[180:183], v[48:51], v[36:39]
    v_mfma_f32_16x16x32_bf16 v[40:43], v[184:187], v[48:51], v[40:43]
    ds_write_b128 v5, v[28:31] offset:32896
    v_mov_b32 v3, 21
    ds_write_b32 v0, v3 offset:32
    v_mfma_f32_16x16x32_bf16 v[44:47], v[188:191], v[48:51], v[44:47]
    s_waitcnt vmcnt(5)
    v_mfma_f32_16x16x32_bf16 v[32:35], v[160:163], v[52:55], v[32:35]
    v_mfma_f32_16x16x32_bf16 v[36:39], v[164:167], v[52:55], v[36:39]
    v_mfma_f32_16x16x32_bf16 v[40:43], v[168:171], v[52:55], v[40:43]
    v_mfma_f32_16x16x32_bf16 v[44:47], v[172:175], v[52:55], v[44:47]
    s_waitcnt vmcnt(4)
    v_mfma_f32_16x16x32_bf16 v[32:35], v[144:147], v[56:59], v[32:35]
    v_mfma_f32_16x16x32_bf16 v[36:39], v[148:151], v[56:59], v[36:39]
    v_mfma_f32_16x16x32_bf16 v[40:43], v[152:155], v[56:59], v[40:43]
    v_mfma_f32_16x16x32_bf16 v[44:47], v[156:159], v[56:59], v[44:47]
    s_waitcnt vmcnt(3)
    v_mfma_f32_16x16x32_bf16 v[32:35], v[128:131], v[60:63], v[32:35]
    s_waitcnt vmcnt(2)
    v_mfma_f32_16x16x32_bf16 v[32:35], v[112:115], v[64:67], v[32:35]
    s_waitcnt vmcnt(1)
    v_mfma_f32_16x16x32_bf16 v[32:35], v[96:99], v[68:71], v[32:35]
    s_waitcnt vmcnt(0)
    v_mfma_f32_16x16x32_bf16 v[32:35], v[80:83], v[72:75], v[32:35]
    v_mfma_f32_16x16x32_bf16 v[36:39], v[132:135], v[60:63], v[36:39]
    v_mfma_f32_16x16x32_bf16 v[36:39], v[116:119], v[64:67], v[36:39]
    v_mfma_f32_16x16x32_bf16 v[36:39], v[100:103], v[68:71], v[36:39]
    v_mfma_f32_16x16x32_bf16 v[36:39], v[84:87], v[72:75], v[36:39]
    v_mfma_f32_16x16x32_bf16 v[40:43], v[136:139], v[60:63], v[40:43]
    v_mfma_f32_16x16x32_bf16 v[40:43], v[120:123], v[64:67], v[40:43]
    v_mfma_f32_16x16x32_bf16 v[40:43], v[104:107], v[68:71], v[40:43]
    v_mfma_f32_16x16x32_bf16 v[40:43], v[88:91], v[72:75], v[40:43]
    ds_write_b128 v2, v[32:35] offset:49152
    v_mfma_f32_16x16x32_bf16 v[44:47], v[140:143], v[60:63], v[44:47]
    v_mfma_f32_16x16x32_bf16 v[44:47], v[124:127], v[64:67], v[44:47]
    v_mfma_f32_16x16x32_bf16 v[44:47], v[108:111], v[68:71], v[44:47]
    v_mfma_f32_16x16x32_bf16 v[44:47], v[92:95], v[72:75], v[44:47]
    ds_write_b128 v5, v[36:39] offset:49152
    s_nop 1
    ds_write_b128 v2, v[40:43] offset:49280
    s_nop 3
    ds_write_b128 v5, v[44:47] offset:49280
    s_waitcnt lgkmcnt(0)
    s_barrier
L_final:
    s_endpgm
L_slow_5:
    s_mov_b32 s77, 0
L_slow_5_l:
    ds_read_b32 v248, v8 offset:16
    s_add_u32 s77, s77, 1
    s_waitcnt lgkmcnt(0)
    v_cmp_gt_u32 vcc, 8, v248
    s_cmp_gt_u32 s77, 0x80000
    s_cbranch_vccz L_back_6
    s_cbranch_scc1 L_back_6
    s_sleep 1
    s_branch L_slow_5_l
L_slow_20:
    s_mov_b32 s77, 0
L_slow_20_l:
    ds_read_b32 v248, v8 offset:16
    s_add_u32 s77, s77, 1
    s_waitcnt lgkmcnt(0)
    v_cmp_gt_u32 vcc, 9, v248
    s_cmp_gt_u32 s77, 0x80000
    s_cbranch_vccz L_back_21
    s_cbranch_scc1 L_back_21
    s_sleep 1
    s_branch L_slow_20_l
L_slow_22:
    s_mov_b32 s77, 0
L_slow_22_l:
    ds_read_b32 v248, v8 offset:32
    s_add_u32 s77, s77, 1
    s_waitcnt lgkmcnt(0)
    v_cmp_gt_u32 vcc, 19, v248
    s_cmp_gt_u32 s77, 0x80000
    s_cbranch_vccz L_back_23
    s_cbranch_scc1 L_back_23
    s_sleep 1
    s_branch L_slow_22_l
L_slow_24:
    s_mov_b32 s77, 0
L_slow_24_l:
    ds_read_b32 v248, v8 offset:32
    s_add_u32 s77, s77, 1
    s_waitcnt lgkmcnt(0)
    v_cmp_gt_u32 vcc, 20, v248
    s_cmp_gt_u32 s77, 0x80000
    s_cbranch_vccz L_back_25
    s_cbranch_scc1 L_back_25
    s_sleep 1
    s_branch L_slow_24_l
L_slow_26:
    s_mov_b32 s77, 0
L_slow_26_l:
    ds_read_b32 v248, v8 offset:32
    s_add_u32 s77, s77, 1
    s_waitcnt lgkmcnt(0)
    v_cmp_gt_u32 vcc, 21, v248
    s_cmp_gt_u32 s77, 0x80000
    s_cbranch_vccz L_back_27
    s_cbranch_scc1 L_back_27
    s_sleep 1
    s_branch L_slow_26_l
L_slow_43:
    s_mov_b32 s77, 0
L_slow_43_l:
    ds_read_b32 v9, v8 offset:32
    s_add_u32 s77, s77, 1
    s_waitcnt lgkmcnt(0)
    v_cmp_gt_u32 vcc, 17, v9
    s_cmp_gt_u32 s77, 0x80000
    s_cbranch_vccz L_back_44
    s_cbranch_scc1 L_back_44
    s_sleep 1
    s_branch L_slow_43_l
L_end:
    s_endpgm
.section .rodata,"a"
.p2align 6
.amdhsa_kernel recurrent_scan__spectral_gfnet__dense_activation_relu__prompt_kernel
  .amdhsa_next_free_vgpr 256
  .amdhsa_next_free_sgpr 102
  .amdhsa_accum_offset 256
  .amdhsa_group_segment_fixed_size 0
  .amdhsa_kernarg_size 72
  .amdhsa_user_sgpr_count 2
  .amdhsa_user_sgpr_kernarg_segment_ptr 1
  .amdhsa_system_sgpr_workgroup_id_x 1
.end_amdhsa_kernel
```
